```python
import torch

def _softmax(x, axis=-1):
    return torch.softmax(x, dim=axis)
def _gelu(x):
    return torch.nn.functional.gelu(x, approximate="tanh")
def _silu(x):
    return torch.nn.functional.silu(x)
def _sigmoid(x):
    return torch.sigmoid(x)
def _layernorm(x, axis=-1, eps=1e-5):
    m = x.mean(dim=axis, keepdim=True)
    v = x.var(dim=axis, keepdim=True, unbiased=False)
    return (x - m) / torch.sqrt(v + eps)
def _scatter_add(tgt, idx, src, axis=0):
    return tgt.clone().index_add_(axis, idx, src)
def _segment_sum(src, seg, n):
    out = torch.zeros((n,) + src.shape[1:], dtype=src.dtype)
    return out.index_add_(0, seg, src)
def _pad(x, pw):
    flat = tuple(v for pair in reversed(pw) for v in pair)
    return torch.nn.functional.pad(x, flat)

kernel_name = 'concat_heads__ssm_conv_h3__spectral_fnet__prompt'

def setup_inputs():

    _w = (lambda a: (lambda t: t.to(torch.bfloat16) if t.is_floating_point() else t)(torch.as_tensor(a)))
    def _A_setup():
        B, S, D = 1, 2048, 512
        ks = 4
        return {
            "q": _w((lambda *s: torch.randn(*s, dtype=torch.bfloat16) * 0.05)(B, S, D)),
            "k": _w((lambda *s: torch.randn(*s, dtype=torch.bfloat16) * 3.2)(B, S, D)),
            "v": _w((lambda *s: torch.randn(*s, dtype=torch.bfloat16) * 3.2)(B, S, D)),
            "shift_k": _w((lambda *s: torch.randn(*s, dtype=torch.bfloat16) * 3.2)(D, ks) * 0.5),
            "ssm_k": _w((lambda *s: torch.randn(*s, dtype=torch.bfloat16) * 3.2)(D, S) * (1.0 / S ** 0.5)),
            "ssm_D": _w((lambda *s: torch.randn(*s, dtype=torch.bfloat16) * 3.2)(D)),
        }
    _A_in = _A_setup()

    def _B_setup():
        B, S, D = 1, 2048, 512
        ns = torch.arange(S)[:, None] * torch.arange(S)[None, :]
        nd = torch.arange(D)[:, None] * torch.arange(D)[None, :]
        Ws_re = torch.cos(-2.0 * torch.pi * ns / S).to(float)
        Ws_im = torch.sin(-2.0 * torch.pi * ns / S).to(float)
        Wd_re = torch.cos(-2.0 * torch.pi * nd / D).to(float)
        Wd_im = torch.sin(-2.0 * torch.pi * nd / D).to(float)
        return {
            "x": _w((lambda *s: torch.randn(*s, dtype=torch.bfloat16) * 0.05)(B, S, D)),
            "dft_seq_re": _w(Ws_re),
            "dft_seq_im": _w(Ws_im),
            "dft_hid_re": _w(Wd_re),
            "dft_hid_im": _w(Wd_im),
        }
    _B_in = _B_setup()

    return {
        "A_q": _A_in["q"],
        "A_k": _A_in["k"],
        "A_v": _A_in["v"],
        "A_shift_k": _A_in["shift_k"],
        "A_ssm_k": _A_in["ssm_k"],
        "A_ssm_D": _A_in["ssm_D"],
        "B_x": _B_in["x"],
        "B_dft_seq_re": _B_in["dft_seq_re"],
        "B_dft_seq_im": _B_in["dft_seq_im"],
        "B_dft_hid_re": _B_in["dft_hid_re"],
        "B_dft_hid_im": _B_in["dft_hid_im"],
    }

def reference(A_q, A_k, A_v, A_shift_k, A_ssm_k, A_ssm_D, B_x, B_dft_seq_re, B_dft_seq_im, B_dft_hid_re, B_dft_hid_im):
    def _A_ref(q, k, v, shift_k, ssm_k, ssm_D):
        B, S, D = q.shape
        ks = shift_k.shape[-1]
        k_pad = _pad(k, ((0, 0), (ks - 1, 0), (0, 0)))
        k_shift = torch.zeros_like(k)
        for t in range(ks):
            k_shift = k_shift + k_pad[:, t:t + S, :] * shift_k[:, ks - 1 - t][None, None, :]
        kv = k_shift * v
        L = 2 * S
        kv_pad = _pad(kv, ((0, 0), (0, S), (0, 0)))
        kf_pad = _pad(ssm_k, ((0, 0), (0, S)))
        kv_f = (lambda x, axes=(-2,-1): torch.fft.rfft2(x.float(), dim=axes))(kv_pad[:, None, :, :], axes=(1, 2))
        kf_f = (lambda x, axes=(-2,-1): torch.fft.rfft2(x.float(), dim=axes))(kf_pad[:, None, :], axes=(1, 2))
        kf_f = (lambda x, *d: x.permute(*d))(kf_f, 1, 2, 0)
        y_f = kv_f * kf_f[None, :, :, :]
        y = (lambda x, s, axes=(-2,-1): torch.fft.irfft2(x, s=s, dim=axes).to(torch.bfloat16))(y_f, (1, L), axes=(1, 2))[:, 0, :S, :]
        y = y + kv * ssm_D[None, None, :]
        return q * y

    def _B_ref(x, dft_seq_re, dft_seq_im, dft_hid_re, dft_hid_im):
        a = torch.einsum("bsd,ed->bse", x, dft_hid_re)
        b = torch.einsum("bsd,ed->bse", x, dft_hid_im)
        y = torch.einsum("ts,bse->bte", dft_seq_re, a) - torch.einsum("ts,bse->bte", dft_seq_im, b)
        return y

    a = _A_ref(A_q, A_k, A_v, A_shift_k, A_ssm_k, A_ssm_D)
    b = _B_ref(B_x, B_dft_seq_re, B_dft_seq_im, B_dft_hid_re, B_dft_hid_im)
    return torch.concatenate([a, b], axis=-1)
```

```asm
; @launch grid=(256,1,1) block=(512,1,1) lds=85376
.amdgcn_target "amdgcn-amd-amdhsa--gfx950"
.text
.globl concat_heads__ssm_conv_h3__spectral_fnet__prompt_kernel
.p2align 12
.p2align 8
.type concat_heads__ssm_conv_h3__spectral_fnet__prompt_kernel,@function
concat_heads__ssm_conv_h3__spectral_fnet__prompt_kernel:
    s_load_dwordx16 s[4:19], s[0:1], 0
    s_load_dwordx2 s[28:29], s[0:1], 104
    s_load_dwordx2 s[20:21], s[0:1], 88
    v_lshrrev_b32 v1, 6, v0
    s_cmp_ge_u32 s2, 256
    s_cbranch_scc1 L_end
    v_readfirstlane_b32 s36, v1
    s_and_b32 s34, s2, 7
    s_xor_b32 s34, s34, 1
    s_lshr_b32 s35, s2, 3
    v_and_b32 v14, 63, v0
    s_lshl_b32 s38, s34, 7
    s_mov_b32 s40, 261652480
    s_cmp_ge_u32 s36, 4
    s_cbranch_scc1 L_A
    s_getpc_b64 s[32:33]
    s_lshl_b32 s37, s35, 7
    s_and_b32 s32, s32, 0xfffff000
    v_lshl_add_u32 v2, v1, 12, s37
    global_load_dword v15, v2, s[32:33]
    s_lshl_b32 s3, s2, 2
    s_lshr_b32 s3, 0x65427130, s3
    s_and_b32 s37, s35, 1
    s_and_b32 s39, s3, 3
    s_lshl1_add_u32 s37, s39, s37
    s_bfe_u32 s3, s3, 0x10002
    s_lshr_b32 s43, s35, 1
    s_lshl4_add_u32 s43, s3, s43
    v_lshrrev_b32 v3, 2, v0
    v_lshl_add_u32 v3, v3, 5, s43
    v_sub_u32 v4, 0, v3
    v_and_b32 v4, 0x7ff, v4
    v_lshrrev_b32 v2, 3, v14
    v_and_b32 v2, 2, v2
    v_xor_b32 v2, v2, v14
    v_and_b32 v2, 3, v2
    s_lshl_b32 s39, s37, 6
    v_lshl_add_u32 v3, v3, 6, v2
    v_lshl_add_u32 v4, v4, 6, v2
    v_lshl_add_u32 v3, v3, 4, s39
    s_sub_u32 s39, 960, s39
    v_lshl_add_u32 v4, v4, 4, s39
    s_lshl_b32 s42, s36, 10
    s_add_u32 m0, s42, 77184
    s_lshl_b32 s44, s34, 9
    v_lshl_add_u32 v5, v14, 4, s44
    v_lshl_add_u32 v6, v14, 4, s38
    s_waitcnt lgkmcnt(0)
    global_load_lds_dwordx4 v3, s[16:17] nt
    s_add_u32 m0, s42, 81280
    s_cmp_lg_u32 s36, 3
    global_load_lds_dwordx4 v4, s[16:17] nt
    s_cbranch_scc1 L_B00
    s_mov_b32 m0, 50688
    s_mov_b32 exec_hi, 0
    global_load_lds_dwordx4 v5, s[10:11]
    s_mov_b32 m0, 51200
    s_mov_b32 exec_lo, 0xff
    global_load_lds_dwordx4 v6, s[14:15]
    s_mov_b64 exec, -1
L_B00:
    s_barrier
    s_load_dword s41, s[28:29], s40
    s_branch L_B
L_A:
    v_and_b32 v0, 255, v0
    s_sub_u32 s36, s36, 4
    v_lshrrev_b32 v1, 3, v0
    v_and_b32 v2, 7, v0
    s_lshl_b32 s37, s35, 16
    s_add_u32 s37, s37, s38
    v_lshl_add_u32 v3, v1, 11, s37
    v_lshl_add_u32 v3, v2, 4, v3
    v_add_u32 v4, 0xfffff400, v3
    v_add_u32 v5, 0xfffff800, v3
    v_add_u32 v6, 0xfffffc00, v3
    s_mov_b32 s26, 0x200000
    s_mov_b32 s27, 0x20000
    s_mov_b32 s30, 12582912
    s_mov_b32 s31, s27
    v_and_b32 v75, 15, v14
    v_lshrrev_b32 v74, 4, v14
    v_and_b32 v7, 8, v14
    v_lshl_add_u32 v7, v7, 4, v2
    v_lshl_add_u32 v7, v74, 13, v7
    v_lshlrev_b32 v12, 4, v7
    s_lshl_b32 s48, s36, 20
    s_lshl_b32 s49, s35, 12
    s_add_u32 s48, s48, s49
    s_add_u32 s48, s48, s38
    s_add_u32 s49, s48, 0x80000
    s_mov_b32 s22, 0x400000
    s_mov_b32 s23, s27
    v_mov_b32 v64, 4286709633
    v_mov_b32 v65, v64
    v_mov_b32 v66, v64
    v_mov_b32 v67, v64
    s_waitcnt lgkmcnt(0)
    s_load_dword s41, s[28:29], s40
    s_mov_b64 s[24:25], s[6:7]
    s_add_u32 s28, s28, 255852544
    s_addc_u32 s29, s29, 0
    s_barrier
    buffer_load_dwordx4 v[28:31], v3, s[24:27], 0 offen
    buffer_load_dwordx4 v[32:35], v3, s[24:27], 0 offen offset:1024
    buffer_load_dwordx4 v[16:19], v4, s[24:27], 0 offen
    buffer_load_dwordx4 v[20:23], v5, s[24:27], 0 offen
    buffer_load_dwordx4 v[24:27], v6, s[24:27], 0 offen
    buffer_store_dwordx4 v[64:67], v12, s[20:23], s48 offen
    buffer_store_dwordx4 v[64:67], v12, s[20:23], s49 offen
    global_load_dwordx4 v[36:39], v3, s[8:9] nt
    global_load_dwordx4 v[40:43], v3, s[8:9] offset:1024 nt
    s_lshl_b32 s42, s35, 17
    s_lshl_b32 s43, s36, 15
    s_add_u32 s42, s42, s43
    s_add_u32 s42, s42, s38
    s_add_u32 s43, s42, 0x4000
    s_mov_b64 s[16:17], s[20:21]
    s_mov_b64 s[18:19], s[22:23]
    s_lshr_b32 s54, s36, 1
    s_and_b32 s55, s36, 1
    v_lshlrev_b32 v8, 2, v0
    v_and_b32 v4, 124, v8
    v_mov_b32 v73, 0
    ds_write_b32 v4, v73 offset:50560
    ds_write_b32 v8, v73 offset:33024
    ds_write_b32 v4, v73
    ds_write_b32 v4, v73 offset:16512
    v_mul_u32_u24 v9, 1040, v2
    v_add_u32 v9, 42240, v9
    v_lshl_add_u32 v10, v1, 2, v9
    v_xor_b32 v9, 12, v10
    s_and_b32 s56, s35, 3
    v_xor_b32 v4, s56, v14
    v_and_b32 v5, 1, v4
    v_and_b32 v4, 14, v4
    v_lshl_add_u32 v5, v5, 4, v4
    v_lshl_add_u32 v5, v74, 5, v5
    s_mul_i32 s57, s36, 2080
    v_lshl_add_u32 v11, v5, 3, s57
    v_lshlrev_b32 v86, 6, v2
    v_lshlrev_b32 v85, 4, v2
    s_mov_b32 s50, 0x05040100
    s_mov_b32 s51, 0x07060302
    s_lshl_b32 s56, s36, 2
    v_mov_b32 v68, s56
    v_xor_b32 v69, 4, v68
    s_getreg_b32 s52, hwreg(HW_REG_XCC_ID, 0, 4)
    s_lshl_b32 s46, s34, 10
    s_add_u32 s46, s46, 5767168
    s_lshl_b32 s47, s36, 7
    s_lshl2_add_u32 s56, s35, s47
    v_mov_b32 v4, s56
    s_lshr_b32 s56, s35, 3
    s_lshl_b32 s56, s56, 7
    v_and_b32 v5, 31, v14
    v_lshl_add_u32 v5, v5, 2, s56
    buffer_load_dword v80, v8, s[28:31], s46 offen sc1
    s_lshl_b32 s58, s36, 11
    v_lshl_add_u32 v1, v14, 4, s58
    v_lshrrev_b32 v70, 3, v14
    v_lshl_add_u32 v70, v70, 11, v85
    s_lshl1_add_u32 s44, s35, s54
    s_lshl_b32 s44, s44, 11
    s_add_u32 s44, s44, s38
    s_add_u32 s45, s44, 0x200000
    s_mov_b32 s59, 0
    v_lshlrev_b32 v15, 9, v14
    v_and_b32 v15, 0x7800, v15
    s_mul_i32 s56, s54, 16512
    s_lshl_b32 s60, s55, 10
    s_add_u32 s56, s56, s60
    v_lshl_add_u32 v8, v14, 3, s56
    v_sub_u32 v6, v75, v74
    s_lshl_b32 s60, s55, 3
    s_sub_u32 s60, 16, s60
    v_add_u32 v6, s60, v6
    s_add_u32 s60, s54, 2
    v_bfe_u32 v2, v6, 2, 2
    v_xor_b32 v2, s60, v2
    v_lshlrev_b32 v2, 4, v2
    v_lshl_add_u32 v60, v6, 6, v2
    v_xor_b32 v61, 32, v60
    v_add_u32 v6, -4, v6
    v_bfe_u32 v2, v6, 2, 2
    v_xor_b32 v2, s60, v2
    v_lshlrev_b32 v2, 4, v2
    v_lshl_add_u32 v62, v6, 6, v2
    v_xor_b32 v63, 32, v62
    v_and_b32 v6, 3, v75
    v_and_b32 v75, 12, v75
    v_lshl_add_u32 v75, v75, 10, v6
    v_lshrrev_b32 v6, 1, v74
    v_lshl_add_u32 v75, v75, 1, v6
    s_lshl_b32 s56, s55, 19
    v_lshl_add_u32 v75, v75, 4, s56
    v_and_b32 v74, 1, v74
    s_lshl_b32 s56, s55, 20
    s_sub_u32 s56, 0x180000, s56
    v_mad_u32_u24 v75, v74, s56, v75
    s_lshl_b32 s60, s36, 12
    v_lshl_add_u32 v2, v14, 4, s60
    v_xor_b32 v7, 0x1000, v2
    v_and_b32 v72, 0x3ff, v3
    v_lshlrev_b32 v6, 1, v3
    v_sub_u32 v72, v6, v72
    v_lshl_add_u32 v74, v14, 4, s57
    s_waitcnt lgkmcnt(0)
    s_add_u32 s41, s41, 2654435760
    s_add_u32 s52, s52, s41
    v_mov_b32 v13, s52
    s_barrier
    ds_read_b128 v[44:47], v86 offset:50688
    ds_read_b128 v[48:51], v86 offset:50704
    ds_read_b128 v[52:55], v86 offset:50720
    ds_read_b128 v[56:59], v86 offset:50736
    ds_read_b128 v[76:79], v85 offset:51200
    s_setprio 2
    s_waitcnt vmcnt(3)
    buffer_store_dword v13, v4, s[28:31], s46 offen
    v_perm_b32 v96, v16, v20, s50
    v_perm_b32 v97, v16, v20, s51
    v_perm_b32 v98, v17, v21, s50
    v_perm_b32 v99, v17, v21, s51
    v_perm_b32 v100, v18, v22, s50
    v_perm_b32 v101, v18, v22, s51
    v_perm_b32 v102, v19, v23, s50
    v_perm_b32 v103, v19, v23, s51
    v_perm_b32 v104, v20, v24, s50
    v_perm_b32 v105, v20, v24, s51
    v_perm_b32 v106, v21, v25, s50
    v_perm_b32 v107, v21, v25, s51
    v_perm_b32 v108, v22, v26, s50
    v_perm_b32 v109, v22, v26, s51
    v_perm_b32 v110, v23, v27, s50
    v_perm_b32 v111, v23, v27, s51
    v_perm_b32 v112, v24, v28, s50
    v_perm_b32 v113, v24, v28, s51
    v_perm_b32 v114, v25, v29, s50
    v_perm_b32 v115, v25, v29, s51
    v_perm_b32 v116, v26, v30, s50
    v_perm_b32 v117, v26, v30, s51
    v_perm_b32 v118, v27, v31, s50
    v_perm_b32 v119, v27, v31, s51
    v_perm_b32 v120, v28, v32, s50
    v_perm_b32 v121, v28, v32, s51
    v_perm_b32 v122, v29, v33, s50
    v_perm_b32 v123, v29, v33, s51
    v_perm_b32 v124, v30, v34, s50
    v_perm_b32 v125, v30, v34, s51
    v_perm_b32 v126, v31, v35, s50
    v_perm_b32 v127, v31, v35, s51
    s_waitcnt lgkmcnt(0)
    v_dot2_f32_bf16 v129, v112, v44, 0
    v_dot2_f32_bf16 v128, v120, v44, 0
    v_dot2_f32_bf16 v131, v113, v46, 0
    v_dot2_f32_bf16 v130, v121, v46, 0
    v_dot2_f32_bf16 v133, v114, v48, 0
    v_dot2_f32_bf16 v132, v122, v48, 0
    v_dot2_f32_bf16 v135, v115, v50, 0
    v_dot2_f32_bf16 v134, v123, v50, 0
    v_dot2_f32_bf16 v137, v116, v52, 0
    v_dot2_f32_bf16 v136, v124, v52, 0
    v_dot2_f32_bf16 v139, v117, v54, 0
    v_dot2_f32_bf16 v138, v125, v54, 0
    v_dot2_f32_bf16 v141, v118, v56, 0
    v_dot2_f32_bf16 v140, v126, v56, 0
    v_dot2_f32_bf16 v143, v119, v58, 0
    v_dot2_f32_bf16 v142, v127, v58, 0
    v_dot2_f32_bf16 v129, v96, v45, v129
    v_dot2_f32_bf16 v128, v104, v45, v128
    v_dot2_f32_bf16 v131, v97, v47, v131
    v_dot2_f32_bf16 v130, v105, v47, v130
    v_dot2_f32_bf16 v133, v98, v49, v133
    v_dot2_f32_bf16 v132, v106, v49, v132
    v_dot2_f32_bf16 v135, v99, v51, v135
    v_dot2_f32_bf16 v134, v107, v51, v134
    v_dot2_f32_bf16 v137, v100, v53, v137
    v_dot2_f32_bf16 v136, v108, v53, v136
    v_dot2_f32_bf16 v139, v101, v55, v139
    v_dot2_f32_bf16 v138, v109, v55, v138
    v_dot2_f32_bf16 v141, v102, v57, v141
    v_dot2_f32_bf16 v140, v110, v57, v140
    v_dot2_f32_bf16 v143, v103, v59, v143
    v_dot2_f32_bf16 v142, v111, v59, v142
    v_lshlrev_b32 v160, 16, v76
    v_lshlrev_b32 v161, 16, v76
    v_and_b32 v162, 0xffff0000, v76
    v_and_b32 v163, 0xffff0000, v76
    v_lshlrev_b32 v164, 16, v77
    v_lshlrev_b32 v165, 16, v77
    v_and_b32 v166, 0xffff0000, v77
    v_and_b32 v167, 0xffff0000, v77
    v_lshlrev_b32 v168, 16, v78
    v_lshlrev_b32 v169, 16, v78
    v_and_b32 v170, 0xffff0000, v78
    v_and_b32 v171, 0xffff0000, v78
    v_lshlrev_b32 v172, 16, v79
    v_lshlrev_b32 v173, 16, v79
    v_and_b32 v174, 0xffff0000, v79
    v_and_b32 v175, 0xffff0000, v79
    s_waitcnt vmcnt(2)
    buffer_load_dword v6, v5, s[28:31], s46 offen sc1
    buffer_load_dword v15, v15, s[20:23], s42 offen sc1 nt
    v_lshlrev_b32 v145, 16, v36
    v_lshlrev_b32 v144, 16, v40
    v_pk_mul_f32 v[128:129], v[128:129], v[144:145]
    v_cvt_pk_bf16_f32 v88, v128, v129
    v_and_b32 v147, 0xffff0000, v36
    v_and_b32 v146, 0xffff0000, v40
    v_pk_mul_f32 v[130:131], v[130:131], v[146:147]
    v_cvt_pk_bf16_f32 v89, v130, v131
    ds_write2_b32 v9, v88, v89 offset0:0 offset1:32
    v_lshlrev_b32 v149, 16, v37
    v_lshlrev_b32 v148, 16, v41
    v_pk_mul_f32 v[132:133], v[132:133], v[148:149]
    v_cvt_pk_bf16_f32 v90, v132, v133
    v_and_b32 v151, 0xffff0000, v37
    v_and_b32 v150, 0xffff0000, v41
    v_pk_mul_f32 v[134:135], v[134:135], v[150:151]
    v_cvt_pk_bf16_f32 v91, v134, v135
    ds_write2_b32 v9, v90, v91 offset0:64 offset1:96
    v_lshlrev_b32 v153, 16, v38
    v_lshlrev_b32 v152, 16, v42
    v_pk_mul_f32 v[136:137], v[136:137], v[152:153]
    v_cvt_pk_bf16_f32 v92, v136, v137
    v_and_b32 v155, 0xffff0000, v38
    v_and_b32 v154, 0xffff0000, v42
    v_pk_mul_f32 v[138:139], v[138:139], v[154:155]
    v_cvt_pk_bf16_f32 v93, v138, v139
    ds_write2_b32 v9, v92, v93 offset0:128 offset1:160
    v_lshlrev_b32 v157, 16, v39
    v_lshlrev_b32 v156, 16, v43
    v_pk_mul_f32 v[140:141], v[140:141], v[156:157]
    v_cvt_pk_bf16_f32 v94, v140, v141
    v_and_b32 v159, 0xffff0000, v39
    v_and_b32 v158, 0xffff0000, v43
    v_pk_mul_f32 v[142:143], v[142:143], v[158:159]
    v_cvt_pk_bf16_f32 v95, v142, v143
    ds_write2_b32 v9, v94, v95 offset0:192 offset1:224
    ds_write_b32 v68, v64 offset:50608
L_A_ts:
    ds_read_b128 v[16:19], v73 offset:50608
    ds_read_b128 v[36:39], v11 offset:42240
    ds_read_b128 v[40:43], v11 offset:43280
    s_waitcnt lgkmcnt(2)
    v_min3_u32 v16, v16, v17, v18
    v_min_u32 v16, v16, v19
    v_cmp_eq_u32 vcc, 0, v16
    s_cbranch_vccnz L_A_ts
    s_waitcnt lgkmcnt(1)
    buffer_store_dwordx4 v[36:39], v12, s[20:23], s48 offen
    s_waitcnt lgkmcnt(0)
    buffer_store_dwordx4 v[40:43], v12, s[20:23], s49 offen
    v_pk_mul_f32 v[44:45], v[128:129], v[160:161]
    v_pk_mul_f32 v[46:47], v[130:131], v[162:163]
    v_pk_mul_f32 v[48:49], v[132:133], v[164:165]
    v_pk_mul_f32 v[50:51], v[134:135], v[166:167]
    v_pk_mul_f32 v[52:53], v[136:137], v[168:169]
    v_pk_mul_f32 v[54:55], v[138:139], v[170:171]
    v_pk_mul_f32 v[56:57], v[140:141], v[172:173]
    v_pk_mul_f32 v[58:59], v[142:143], v[174:175]
    s_branch L_A_w1
L_A_poll1:
    s_mov_b32 s60, 0
L_A_poll1a:
    buffer_load_dword v6, v5, s[28:31], s46 offen sc1
    s_add_u32 s60, s60, 1
    s_waitcnt vmcnt(0)
    v_cmp_ne_u32 vcc, s52, v6
    s_cbranch_vccz L_A_go1
    s_and_b32 s61, s60, 15
    s_cbranch_scc1 L_A_poll1a
    s_add_u32 s61, s38, 5775360
    s_lshl_b32 s53, s35, 2
    v_mov_b32 v9, s53
    buffer_store_dword v13, v9, s[28:31], s61 offen sc1
    v_and_b32 v9, 31, v14
    v_lshlrev_b32 v9, 2, v9
    buffer_load_dword v6, v9, s[28:31], s61 offen sc1
    s_waitcnt vmcnt(0)
    v_cmp_ne_u32 vcc, s52, v6
    v_subrev_u32 v6, s41, v6
    v_cmp_gt_u32 s[32:33], 16, v6
    s_and_b64 vcc, vcc, s[32:33]
    s_cbranch_vccnz L_A_slow1
    s_cmp_lt_u32 s60, 524288
    s_cbranch_scc1 L_A_poll1a
    s_branch L_A_go1
L_A_uretry:
    s_mov_b32 s60, 0
L_A_uretrya:
    s_mov_b64 exec, vcc
    buffer_load_dwordx4 v[88:91], v70, s[16:19], s42 offen sc1
    buffer_load_dwordx4 v[92:95], v70, s[16:19], s43 offen sc1
    s_add_u32 s60, s60, 1
    s_and_b32 s61, s60, 31
    s_waitcnt vmcnt(0)
    v_max3_u32 v96, v88, v89, v90
    v_max3_u32 v97, v91, v92, v93
    v_max3_u32 v96, v96, v94, v95
    v_max_u32 v96, v96, v97
    v_cmp_le_u32 vcc, v64, v96
    s_mov_b64 exec, -1
    s_cbranch_vccz L_A_uok
    s_cbranch_scc1 L_A_uretrya
    v_cmp_eq_u32 s[32:33], v64, v88
    v_cmp_eq_u32 vcc, v64, v89
    s_or_b64 s[32:33], s[32:33], vcc
    v_cmp_eq_u32 vcc, v64, v90
    s_or_b64 s[32:33], s[32:33], vcc
    v_cmp_eq_u32 vcc, v64, v91
    s_or_b64 s[32:33], s[32:33], vcc
    v_cmp_eq_u32 vcc, v64, v92
    s_or_b64 s[32:33], s[32:33], vcc
    v_cmp_eq_u32 vcc, v64, v93
    s_or_b64 s[32:33], s[32:33], vcc
    v_cmp_eq_u32 vcc, v64, v94
    s_or_b64 s[32:33], s[32:33], vcc
    v_cmp_eq_u32 vcc, v64, v95
    s_or_b64 s[32:33], s[32:33], vcc
    s_cbranch_scc0 L_A_uok
    s_mov_b64 vcc, s[32:33]
    s_cmp_lt_u32 s60, 524288
    s_cbranch_scc1 L_A_uretrya
    s_branch L_A_uok
L_A_slow1:
    s_mov_b32 s59, 1
    s_add_u32 s16, s28, 6291456
    s_addc_u32 s17, s29, 0
    buffer_store_dwordx4 v[36:39], v12, s[20:23], s48 offen sc1
    buffer_store_dwordx4 v[40:43], v12, s[20:23], s49 offen sc1
    buffer_store_dwordx4 v[36:39], v12, s[16:19], s48 offen sc1
    buffer_store_dwordx4 v[40:43], v12, s[16:19], s49 offen sc1
    s_add_u32 s47, s46, 16384
    v_mov_b32 v9, s41
    s_waitcnt vmcnt(0)
    buffer_store_dword v9, v4, s[28:31], s47 offen sc1
    s_mov_b32 s60, 0
L_A_poll1s:
    buffer_load_dword v6, v5, s[28:31], s47 offen sc1
    s_add_u32 s60, s60, 1
    s_waitcnt vmcnt(0)
    v_cmp_ne_u32 vcc, s41, v6
    s_cbranch_vccz L_A_go1
    s_cmp_lt_u32 s60, 524288
    s_cbranch_scc1 L_A_poll1s
    s_branch L_A_go1
.p2align 12
L_A_w0:
    s_waitcnt vmcnt(3)
    v_cmp_ne_u32 vcc, s52, v6
    s_cbranch_vccnz L_A_poll1
L_A_go1:
    buffer_load_dwordx4 v[88:91], v70, s[16:19], s42 offen sc1
    buffer_load_dwordx4 v[92:95], v70, s[16:19], s43 offen sc1
L_A_hs:
    ds_read_b128 v[96:99], v73 offset:50624
    s_waitcnt lgkmcnt(0)
    v_min3_u32 v96, v96, v97, v98
    v_min_u32 v96, v96, v99
    v_cmp_eq_u32 vcc, 0, v96
    s_cbranch_vccnz L_A_hs
    ds_read_b64 v[128:129], v8 offset:32
    ds_read_b64 v[130:131], v8 offset:64
    ds_read_b64 v[132:133], v8 offset:2080
    ds_read_b64 v[134:135], v8 offset:2112
    ds_read_b64 v[136:137], v8 offset:4128
    ds_read_b64 v[138:139], v8 offset:4160
    ds_read_b64 v[140:141], v8 offset:6176
    ds_read_b64 v[142:143], v8 offset:6208
    ds_read_b64 v[144:145], v8 offset:8224
    ds_read_b64 v[146:147], v8 offset:8256
    ds_read_b64 v[148:149], v8 offset:10272
    ds_read_b64 v[150:151], v8 offset:10304
    ds_read_b64 v[152:153], v8 offset:12320
    ds_read_b64 v[154:155], v8 offset:12352
    ds_read_b64 v[156:157], v8 offset:14368
    ds_read_b64 v[158:159], v8 offset:14400
    s_waitcnt vmcnt(0)
    v_max3_u32 v96, v88, v89, v90
    v_max3_u32 v97, v91, v92, v93
    v_max3_u32 v96, v96, v94, v95
    v_max_u32 v96, v96, v97
    v_cmp_le_u32 vcc, v64, v96
    s_cbranch_vccnz L_A_uretry
L_A_uok:
    ds_write_b128 v1, v[88:91] offset:34048
    ds_write_b128 v1, v[92:95] offset:35072
    ds_write_b32 v68, v64 offset:50640
    buffer_store_dwordx4 v[64:67], v70, s[20:23], s42 offen
    buffer_store_dwordx4 v[64:67], v70, s[20:23], s43 offen
L_A_us:
    ds_read_b128 v[24:27], v73 offset:50640
    ds_read_b128 v[28:31], v60 offset:33024
    ds_read_b128 v[32:35], v60 offset:34048
    s_waitcnt lgkmcnt(2)
    v_min3_u32 v24, v24, v25, v26
    v_min_u32 v24, v24, v27
    v_cmp_eq_u32 vcc, 0, v24
    s_cbranch_vccnz L_A_us
    s_waitcnt lgkmcnt(1)
    v_mfma_f32_16x16x32_bf16 v[96:99], v[128:131], v[28:31], 0
    ds_read_b64 v[160:161], v8 offset:96
    global_load_dwordx4 v[80:83], v3, s[4:5] nt
    v_mfma_f32_16x16x32_bf16 v[100:103], v[132:135], v[28:31], 0
    ds_read_b64 v[162:163], v8 offset:128
    global_load_dwordx4 v[84:87], v3, s[4:5] offset:1024 nt
    v_mfma_f32_16x16x32_bf16 v[104:107], v[136:139], v[28:31], 0
    ds_read_b64 v[164:165], v8 offset:2144
    v_mfma_f32_16x16x32_bf16 v[108:111], v[140:143], v[28:31], 0
    ds_read_b64 v[166:167], v8 offset:2176
    v_mfma_f32_16x16x32_bf16 v[112:115], v[144:147], v[28:31], 0
    ds_read_b64 v[168:169], v8 offset:4192
    v_mfma_f32_16x16x32_bf16 v[116:119], v[148:151], v[28:31], 0
    ds_read_b64 v[170:171], v8 offset:4224
    v_mfma_f32_16x16x32_bf16 v[120:123], v[152:155], v[28:31], 0
    ds_read_b128 v[36:39], v60 offset:35072
    v_mfma_f32_16x16x32_bf16 v[124:127], v[156:159], v[28:31], 0
    s_waitcnt lgkmcnt(7)
    ds_read_b64 v[172:173], v8 offset:6240
    v_mfma_f32_16x16x32_bf16 v[100:103], v[128:131], v[32:35], v[100:103]
    ds_read_b64 v[174:175], v8 offset:6272
    v_mfma_f32_16x16x32_bf16 v[104:107], v[132:135], v[32:35], v[104:107]
    ds_read_b64 v[176:177], v8 offset:8288
    v_mfma_f32_16x16x32_bf16 v[108:111], v[136:139], v[32:35], v[108:111]
    ds_read_b64 v[178:179], v8 offset:8320
    v_mfma_f32_16x16x32_bf16 v[112:115], v[140:143], v[32:35], v[112:115]
    ds_read_b64 v[180:181], v8 offset:10336
    v_mfma_f32_16x16x32_bf16 v[116:119], v[144:147], v[32:35], v[116:119]
    ds_read_b128 v[40:43], v60 offset:36096
    v_mfma_f32_16x16x32_bf16 v[120:123], v[148:151], v[32:35], v[120:123]
    ds_read_b64 v[182:183], v8 offset:10368
    v_mfma_f32_16x16x32_bf16 v[124:127], v[152:155], v[32:35], v[124:127]
    s_waitcnt lgkmcnt(7)
    ds_read_b64 v[184:185], v8 offset:12384
    v_mfma_f32_16x16x32_bf16 v[104:107], v[128:131], v[36:39], v[104:107]
    ds_read_b64 v[186:187], v8 offset:12416
    v_mfma_f32_16x16x32_bf16 v[108:111], v[132:135], v[36:39], v[108:111]
    ds_read_b64 v[188:189], v8 offset:14432
    v_mfma_f32_16x16x32_bf16 v[112:115], v[136:139], v[36:39], v[112:115]
    ds_read_b128 v[16:19], v60 offset:37120
    v_mfma_f32_16x16x32_bf16 v[116:119], v[140:143], v[36:39], v[116:119]
    ds_read_b64 v[190:191], v8 offset:14464
    v_mfma_f32_16x16x32_bf16 v[120:123], v[144:147], v[36:39], v[120:123]
    ds_read_b64 v[192:193], v8 offset:544
    v_mfma_f32_16x16x32_bf16 v[124:127], v[148:151], v[36:39], v[124:127]
    s_waitcnt lgkmcnt(7)
    ds_read_b64 v[194:195], v8 offset:576
    s_waitcnt vmcnt(2)
    buffer_store_dword v13, v4, s[28:31], s46 offen offset:512
    v_mfma_f32_16x16x32_bf16 v[108:111], v[128:131], v[40:43], v[108:111]
    ds_read_b128 v[20:23], v60 offset:38144
    v_mfma_f32_16x16x32_bf16 v[112:115], v[132:135], v[40:43], v[112:115]
    ds_read_b64 v[196:197], v8 offset:2592
    v_mfma_f32_16x16x32_bf16 v[116:119], v[136:139], v[40:43], v[116:119]
    ds_read_b64 v[198:199], v8 offset:2624
    v_mfma_f32_16x16x32_bf16 v[120:123], v[140:143], v[40:43], v[120:123]
    ds_read_b128 v[24:27], v60 offset:39168
    v_mfma_f32_16x16x32_bf16 v[124:127], v[144:147], v[40:43], v[124:127]
    s_waitcnt lgkmcnt(7)
    ds_read_b64 v[200:201], v8 offset:4640
    v_mfma_f32_16x16x32_bf16 v[112:115], v[128:131], v[16:19], v[112:115]
    ds_read_b128 v[28:31], v60 offset:40192
    v_mfma_f32_16x16x32_bf16 v[116:119], v[132:135], v[16:19], v[116:119]
    ds_read_b128 v[32:35], v61 offset:33024
    v_mfma_f32_16x16x32_bf16 v[120:123], v[136:139], v[16:19], v[120:123]
    ds_read_b64 v[202:203], v8 offset:4672
    v_mfma_f32_16x16x32_bf16 v[124:127], v[140:143], v[16:19], v[124:127]
    s_waitcnt lgkmcnt(7)
    ds_read_b64 v[204:205], v8 offset:6688
    v_mfma_f32_16x16x32_bf16 v[116:119], v[128:131], v[20:23], v[116:119]
    ds_read_b64 v[206:207], v8 offset:6720
    v_mfma_f32_16x16x32_bf16 v[120:123], v[132:135], v[20:23], v[120:123]
    ds_read_b64 v[208:209], v8 offset:8736
    v_mfma_f32_16x16x32_bf16 v[124:127], v[136:139], v[20:23], v[124:127]
    s_waitcnt lgkmcnt(7)
    ds_read_b64 v[210:211], v8 offset:8768
    v_mfma_f32_16x16x32_bf16 v[120:123], v[128:131], v[24:27], v[120:123]
    ds_read_b64 v[212:213], v8 offset:10784
    v_mfma_f32_16x16x32_bf16 v[124:127], v[132:135], v[24:27], v[124:127]
    s_waitcnt lgkmcnt(7)
    ds_read_b64 v[214:215], v8 offset:10816
    v_mfma_f32_16x16x32_bf16 v[124:127], v[128:131], v[28:31], v[124:127]
    s_waitcnt lgkmcnt(7)
    ds_read_b128 v[36:39], v61 offset:34048
    v_mfma_f32_16x16x32_bf16 v[96:99], v[160:163], v[32:35], v[96:99]
    ds_read_b64 v[216:217], v8 offset:12832
    v_mfma_f32_16x16x32_bf16 v[100:103], v[164:167], v[32:35], v[100:103]
    ds_read_b128 v[128:131], v62 offset:33024
    v_mfma_f32_16x16x32_bf16 v[104:107], v[168:171], v[32:35], v[104:107]
    ds_read_b64 v[218:219], v8 offset:12864
    v_mfma_f32_16x16x32_bf16 v[108:111], v[172:175], v[32:35], v[108:111]
    ds_read_b128 v[132:135], v62 offset:34048
    v_mfma_f32_16x16x32_bf16 v[112:115], v[176:179], v[32:35], v[112:115]
    ds_read_b64 v[220:221], v8 offset:14880
    v_mfma_f32_16x16x32_bf16 v[116:119], v[180:183], v[32:35], v[116:119]
    ds_read_b64 v[222:223], v8 offset:14912
    v_mfma_f32_16x16x32_bf16 v[120:123], v[184:187], v[32:35], v[120:123]
    ds_read_b128 v[40:43], v61 offset:35072
    v_mfma_f32_16x16x32_bf16 v[124:127], v[188:191], v[32:35], v[124:127]
    s_waitcnt lgkmcnt(7)
    ds_read_b64 v[224:225], v8 offset:608
    v_mfma_f32_16x16x32_bf16 v[100:103], v[160:163], v[36:39], v[100:103]
    ds_read_b128 v[136:139], v62 offset:35072
    v_mfma_f32_16x16x32_bf16 v[104:107], v[164:167], v[36:39], v[104:107]
    ds_read_b64 v[226:227], v8 offset:640
    v_mfma_f32_16x16x32_bf16 v[108:111], v[168:171], v[36:39], v[108:111]
    ds_read_b128 v[140:143], v62 offset:36096
    v_mfma_f32_16x16x32_bf16 v[112:115], v[172:175], v[36:39], v[112:115]
    ds_read_b64 v[228:229], v8 offset:2656
    v_mfma_f32_16x16x32_bf16 v[116:119], v[176:179], v[36:39], v[116:119]
    ds_read_b128 v[16:19], v61 offset:36096
    v_mfma_f32_16x16x32_bf16 v[120:123], v[180:183], v[36:39], v[120:123]
    ds_read_b64 v[230:231], v8 offset:2688
    v_mfma_f32_16x16x32_bf16 v[124:127], v[184:187], v[36:39], v[124:127]
    s_waitcnt lgkmcnt(7)
    ds_read_b128 v[144:147], v62 offset:37120
    v_mfma_f32_16x16x32_bf16 v[104:107], v[160:163], v[40:43], v[104:107]
    ds_read_b64 v[232:233], v8 offset:4704
    v_mfma_f32_16x16x32_bf16 v[108:111], v[164:167], v[40:43], v[108:111]
    ds_read_b64 v[234:235], v8 offset:4736
    v_mfma_f32_16x16x32_bf16 v[112:115], v[168:171], v[40:43], v[112:115]
    ds_read_b128 v[20:23], v61 offset:37120
    v_mfma_f32_16x16x32_bf16 v[116:119], v[172:175], v[40:43], v[116:119]
    ds_read_b64 v[236:237], v8 offset:6752
    v_mfma_f32_16x16x32_bf16 v[120:123], v[176:179], v[40:43], v[120:123]
    ds_read_b128 v[148:151], v62 offset:38144
    v_mfma_f32_16x16x32_bf16 v[124:127], v[180:183], v[40:43], v[124:127]
    s_waitcnt lgkmcnt(7)
    ds_read_b64 v[238:239], v8 offset:6784
    v_mfma_f32_16x16x32_bf16 v[108:111], v[160:163], v[16:19], v[108:111]
    ds_read_b128 v[24:27], v61 offset:38144
    v_mfma_f32_16x16x32_bf16 v[112:115], v[164:167], v[16:19], v[112:115]
    ds_read_b64 v[240:241], v8 offset:8800
    v_mfma_f32_16x16x32_bf16 v[116:119], v[168:171], v[16:19], v[116:119]
    ds_read_b64 v[242:243], v8 offset:8832
    v_mfma_f32_16x16x32_bf16 v[120:123], v[172:175], v[16:19], v[120:123]
    ds_read_b128 v[28:31], v61 offset:39168
    v_mfma_f32_16x16x32_bf16 v[124:127], v[176:179], v[16:19], v[124:127]
    s_waitcnt lgkmcnt(7)
    ds_read_b64 v[244:245], v8 offset:10848
    v_mfma_f32_16x16x32_bf16 v[112:115], v[160:163], v[20:23], v[112:115]
    ds_read_b128 v[32:35], v61 offset:40192
    v_mfma_f32_16x16x32_bf16 v[116:119], v[164:167], v[20:23], v[116:119]
    ds_read_b64 v[246:247], v8 offset:10880
    v_mfma_f32_16x16x32_bf16 v[120:123], v[168:171], v[20:23], v[120:123]
    ds_read_b128 v[152:155], v62 offset:39168
    v_mfma_f32_16x16x32_bf16 v[124:127], v[172:175], v[20:23], v[124:127]
    s_waitcnt lgkmcnt(7)
    ds_read_b64 v[248:249], v8 offset:12896
    v_mfma_f32_16x16x32_bf16 v[116:119], v[160:163], v[24:27], v[116:119]
    ds_read_b128 v[156:159], v62 offset:40192
    v_mfma_f32_16x16x32_bf16 v[120:123], v[164:167], v[24:27], v[120:123]
    ds_read_b64 v[250:251], v8 offset:12928
    v_mfma_f32_16x16x32_bf16 v[124:127], v[168:171], v[24:27], v[124:127]
    s_waitcnt lgkmcnt(7)
    ds_read_b64 v[252:253], v8 offset:14944
    v_mfma_f32_16x16x32_bf16 v[120:123], v[160:163], v[28:31], v[120:123]
    ds_read_b64 v[254:255], v8 offset:14976
    v_mfma_f32_16x16x32_bf16 v[124:127], v[164:167], v[28:31], v[124:127]
    s_waitcnt lgkmcnt(7)
    buffer_load_dword v6, v5, s[28:31], s46 offen offset:512 sc1
    v_mfma_f32_16x16x32_bf16 v[124:127], v[160:163], v[32:35], v[124:127]
    s_cmp_eq_u32 s55, 0
    s_cbranch_scc0 L_A_h1
    v_mfma_f32_16x16x32_bf16 v[100:103], v[196:199], v[128:131], v[100:103]
    ds_read_b128 v[184:187], v63 offset:33024
    v_mfma_f32_16x16x32_bf16 v[104:107], v[200:203], v[128:131], v[104:107]
    v_mfma_f32_16x16x32_bf16 v[116:119], v[212:215], v[128:131], v[116:119]
    ds_read_b128 v[36:39], v63 offset:34048
    v_mfma_f32_16x16x32_bf16 v[120:123], v[216:219], v[128:131], v[120:123]
    v_mfma_f32_16x16x32_bf16 v[100:103], v[192:195], v[132:135], v[100:103]
    ds_read_b128 v[40:43], v63 offset:35072
    v_mfma_f32_16x16x32_bf16 v[104:107], v[196:199], v[132:135], v[104:107]
    v_mfma_f32_16x16x32_bf16 v[116:119], v[208:211], v[132:135], v[116:119]
    ds_read_b128 v[16:19], v63 offset:36096
    v_mfma_f32_16x16x32_bf16 v[120:123], v[212:215], v[132:135], v[120:123]
    v_mfma_f32_16x16x32_bf16 v[104:107], v[192:195], v[136:139], v[104:107]
    ds_read_b128 v[20:23], v63 offset:37120
    v_mfma_f32_16x16x32_bf16 v[116:119], v[204:207], v[136:139], v[116:119]
    v_mfma_f32_16x16x32_bf16 v[120:123], v[208:211], v[136:139], v[120:123]
    ds_read_b128 v[24:27], v63 offset:38144
    v_mfma_f32_16x16x32_bf16 v[116:119], v[200:203], v[140:143], v[116:119]
    v_mfma_f32_16x16x32_bf16 v[120:123], v[204:207], v[140:143], v[120:123]
    ds_read_b128 v[28:31], v63 offset:39168
    v_mfma_f32_16x16x32_bf16 v[116:119], v[196:199], v[144:147], v[116:119]
    v_mfma_f32_16x16x32_bf16 v[120:123], v[200:203], v[144:147], v[120:123]
    ds_read_b128 v[32:35], v63 offset:40192
    v_mfma_f32_16x16x32_bf16 v[116:119], v[192:195], v[148:151], v[116:119]
    v_mfma_f32_16x16x32_bf16 v[120:123], v[196:199], v[148:151], v[120:123]
    s_waitcnt lgkmcnt(13)
    v_mfma_f32_16x16x32_bf16 v[120:123], v[192:195], v[152:155], v[120:123]
    s_waitcnt lgkmcnt(7)
    v_mfma_f32_16x16x32_bf16 v[100:103], v[228:231], v[184:187], v[100:103]
    s_waitcnt lgkmcnt(6)
    v_mfma_f32_16x16x32_bf16 v[100:103], v[224:227], v[36:39], v[100:103]
    s_nop 2
    v_mfma_f32_16x16x32_bf16 v[104:107], v[232:235], v[184:187], v[104:107]
    s_nop 2
    v_mfma_f32_16x16x32_bf16 v[104:107], v[228:231], v[36:39], v[104:107]
    s_waitcnt lgkmcnt(5)
    ds_write_b128 v2, v[100:103] offset:51328
    v_mfma_f32_16x16x32_bf16 v[104:107], v[224:227], v[40:43], v[104:107]
    s_nop 2
    v_mfma_f32_16x16x32_bf16 v[116:119], v[244:247], v[184:187], v[116:119]
    s_nop 2
    v_mfma_f32_16x16x32_bf16 v[116:119], v[240:243], v[36:39], v[116:119]
    v_mfma_f32_16x16x32_bf16 v[116:119], v[236:239], v[40:43], v[116:119]
    s_waitcnt lgkmcnt(5)
    ds_write_b128 v2, v[104:107] offset:52352
    v_mfma_f32_16x16x32_bf16 v[116:119], v[232:235], v[16:19], v[116:119]
    s_waitcnt lgkmcnt(5)
    v_mfma_f32_16x16x32_bf16 v[116:119], v[228:231], v[20:23], v[116:119]
    s_waitcnt lgkmcnt(4)
    v_mfma_f32_16x16x32_bf16 v[116:119], v[224:227], v[24:27], v[116:119]
    s_nop 2
    v_mfma_f32_16x16x32_bf16 v[120:123], v[248:251], v[184:187], v[120:123]
    s_nop 2
    v_mfma_f32_16x16x32_bf16 v[120:123], v[244:247], v[36:39], v[120:123]
    ds_write_b128 v2, v[116:119] offset:53376
    v_mfma_f32_16x16x32_bf16 v[120:123], v[240:243], v[40:43], v[120:123]
    v_mfma_f32_16x16x32_bf16 v[120:123], v[236:239], v[16:19], v[120:123]
    v_mfma_f32_16x16x32_bf16 v[120:123], v[232:235], v[20:23], v[120:123]
    v_mfma_f32_16x16x32_bf16 v[120:123], v[228:231], v[24:27], v[120:123]
    s_waitcnt lgkmcnt(4)
    v_mfma_f32_16x16x32_bf16 v[120:123], v[224:227], v[28:31], v[120:123]
    s_nop 2
    v_mfma_f32_16x16x32_bf16 v[112:115], v[208:211], v[128:131], v[112:115]
    s_nop 2
    v_mfma_f32_16x16x32_bf16 v[112:115], v[204:207], v[132:135], v[112:115]
    ds_write_b128 v2, v[120:123] offset:54400
    v_mfma_f32_16x16x32_bf16 v[112:115], v[200:203], v[136:139], v[112:115]
    v_mfma_f32_16x16x32_bf16 v[112:115], v[196:199], v[140:143], v[112:115]
    ds_write_b32 v68, v64 offset:50560
    v_mfma_f32_16x16x32_bf16 v[112:115], v[192:195], v[144:147], v[112:115]
    s_mov_b32 s60, 0
    v_mfma_f32_16x16x32_bf16 v[112:115], v[240:243], v[184:187], v[112:115]
    s_waitcnt vmcnt(0)
    v_cmp_ne_u32 vcc, s52, v6
    v_mfma_f32_16x16x32_bf16 v[112:115], v[236:239], v[36:39], v[112:115]
    s_cbranch_vccnz L_A_c20
L_A_c30:
    v_mfma_f32_16x16x32_bf16 v[112:115], v[232:235], v[40:43], v[112:115]
    v_mfma_f32_16x16x32_bf16 v[112:115], v[228:231], v[16:19], v[112:115]
    v_mfma_f32_16x16x32_bf16 v[112:115], v[224:227], v[20:23], v[112:115]
    ds_read_b32 v9, v69 offset:50560
    v_mfma_f32_16x16x32_bf16 v[124:127], v[220:223], v[128:131], v[124:127]
    ds_read_b128 v[160:163], v7 offset:51328
    v_mfma_f32_16x16x32_bf16 v[124:127], v[216:219], v[132:135], v[124:127]
    ds_read_b128 v[164:167], v7 offset:52352
    v_mfma_f32_16x16x32_bf16 v[124:127], v[212:215], v[136:139], v[124:127]
    ds_read_b128 v[168:171], v7 offset:53376
    v_mfma_f32_16x16x32_bf16 v[124:127], v[208:211], v[140:143], v[124:127]
    ds_read_b128 v[172:175], v7 offset:54400
    v_mfma_f32_16x16x32_bf16 v[124:127], v[204:207], v[144:147], v[124:127]
    v_mfma_f32_16x16x32_bf16 v[124:127], v[200:203], v[148:151], v[124:127]
    v_mfma_f32_16x16x32_bf16 v[124:127], v[196:199], v[152:155], v[124:127]
    s_waitcnt lgkmcnt(4)
    v_cmp_eq_u32 vcc, 0, v9
    v_mfma_f32_16x16x32_bf16 v[124:127], v[192:195], v[156:159], v[124:127]
    s_waitcnt lgkmcnt(0)
    s_cbranch_vccnz L_A_pw0
L_A_pok0:
    v_mfma_f32_16x16x32_bf16 v[124:127], v[252:255], v[184:187], v[124:127]
    v_add_f32 v96, v96, v160
    v_add_f32 v97, v97, v161
    v_mfma_f32_16x16x32_bf16 v[124:127], v[248:251], v[36:39], v[124:127]
    v_add_f32 v98, v98, v162
    v_add_f32 v99, v99, v163
    v_mfma_f32_16x16x32_bf16 v[124:127], v[244:247], v[40:43], v[124:127]
    v_add_f32 v108, v108, v164
    v_add_f32 v109, v109, v165
    v_mfma_f32_16x16x32_bf16 v[124:127], v[240:243], v[16:19], v[124:127]
    v_add_f32 v110, v110, v166
    v_add_f32 v111, v111, v167
    v_mfma_f32_16x16x32_bf16 v[124:127], v[236:239], v[20:23], v[124:127]
    v_add_f32 v168, v112, v168
    v_add_f32 v169, v113, v169
    v_mfma_f32_16x16x32_bf16 v[124:127], v[232:235], v[24:27], v[124:127]
    v_add_f32 v170, v114, v170
    v_add_f32 v171, v115, v171
    v_mfma_f32_16x16x32_bf16 v[124:127], v[228:231], v[28:31], v[124:127]
    v_cvt_pk_bf16_f32 v176, v168, v169
    v_cvt_pk_bf16_f32 v177, v170, v171
    v_mfma_f32_16x16x32_bf16 v[124:127], v[224:227], v[32:35], v[124:127]
    s_nop 2
    v_mfma_f32_16x16x32_bf16 v[96:99], v[192:195], v[128:131], v[96:99]
    s_nop 2
    v_mfma_f32_16x16x32_bf16 v[96:99], v[224:227], v[184:187], v[96:99]
    v_add_f32 v172, v124, v172
    v_add_f32 v173, v125, v173
    v_mfma_f32_16x16x32_bf16 v[108:111], v[204:207], v[128:131], v[108:111]
    v_add_f32 v174, v126, v174
    v_add_f32 v175, v127, v175
    v_mfma_f32_16x16x32_bf16 v[108:111], v[200:203], v[132:135], v[108:111]
    v_cvt_pk_bf16_f32 v178, v172, v173
    v_cvt_pk_bf16_f32 v179, v174, v175
    v_mfma_f32_16x16x32_bf16 v[108:111], v[196:199], v[136:139], v[108:111]
    s_cmp_lg_u32 s60, 0
    v_permlane16_swap_b32 v176, v178
    v_mfma_f32_16x16x32_bf16 v[108:111], v[192:195], v[140:143], v[108:111]
    v_permlane16_swap_b32 v177, v179
    v_mfma_f32_16x16x32_bf16 v[108:111], v[236:239], v[184:187], v[108:111]
    s_cbranch_scc1 L_A_y10
    buffer_store_dwordx4 v[176:179], v75, s[20:23], s45 offen
L_A_y10:
    v_mfma_f32_16x16x32_bf16 v[108:111], v[232:235], v[36:39], v[108:111]
    v_mfma_f32_16x16x32_bf16 v[108:111], v[228:231], v[40:43], v[108:111]
    v_cvt_pk_bf16_f32 v180, v96, v97
    v_cvt_pk_bf16_f32 v181, v98, v99
    v_mfma_f32_16x16x32_bf16 v[108:111], v[224:227], v[16:19], v[108:111]
    s_nop 7
    v_cvt_pk_bf16_f32 v182, v108, v109
    v_cvt_pk_bf16_f32 v183, v110, v111
    s_nop 0
    v_permlane16_swap_b32 v180, v182
    v_permlane16_swap_b32 v181, v183
    s_cbranch_scc1 L_A_yw
    buffer_store_dwordx4 v[180:183], v75, s[20:23], s44 offen
    s_branch L_A_h2
L_A_w1:
    s_branch L_A_w2
L_A_h1:
    v_mfma_f32_16x16x32_bf16 v[96:99], v[192:195], v[128:131], v[96:99]
    ds_read_b128 v[184:187], v63 offset:33024
    v_mfma_f32_16x16x32_bf16 v[108:111], v[204:207], v[128:131], v[108:111]
    v_mfma_f32_16x16x32_bf16 v[112:115], v[208:211], v[128:131], v[112:115]
    ds_read_b128 v[36:39], v63 offset:34048
    v_mfma_f32_16x16x32_bf16 v[124:127], v[220:223], v[128:131], v[124:127]
    v_mfma_f32_16x16x32_bf16 v[108:111], v[200:203], v[132:135], v[108:111]
    ds_read_b128 v[40:43], v63 offset:35072
    v_mfma_f32_16x16x32_bf16 v[112:115], v[204:207], v[132:135], v[112:115]
    v_mfma_f32_16x16x32_bf16 v[124:127], v[216:219], v[132:135], v[124:127]
    ds_read_b128 v[16:19], v63 offset:36096
    v_mfma_f32_16x16x32_bf16 v[108:111], v[196:199], v[136:139], v[108:111]
    v_mfma_f32_16x16x32_bf16 v[112:115], v[200:203], v[136:139], v[112:115]
    ds_read_b128 v[20:23], v63 offset:37120
    v_mfma_f32_16x16x32_bf16 v[124:127], v[212:215], v[136:139], v[124:127]
    v_mfma_f32_16x16x32_bf16 v[108:111], v[192:195], v[140:143], v[108:111]
    ds_read_b128 v[24:27], v63 offset:38144
    v_mfma_f32_16x16x32_bf16 v[112:115], v[196:199], v[140:143], v[112:115]
    v_mfma_f32_16x16x32_bf16 v[124:127], v[208:211], v[140:143], v[124:127]
    ds_read_b128 v[28:31], v63 offset:39168
    v_mfma_f32_16x16x32_bf16 v[112:115], v[192:195], v[144:147], v[112:115]
    v_mfma_f32_16x16x32_bf16 v[124:127], v[204:207], v[144:147], v[124:127]
    ds_read_b128 v[32:35], v63 offset:40192
    v_mfma_f32_16x16x32_bf16 v[124:127], v[200:203], v[148:151], v[124:127]
    s_waitcnt lgkmcnt(13)
    v_mfma_f32_16x16x32_bf16 v[124:127], v[196:199], v[152:155], v[124:127]
    s_waitcnt lgkmcnt(11)
    v_mfma_f32_16x16x32_bf16 v[124:127], v[192:195], v[156:159], v[124:127]
    s_waitcnt lgkmcnt(7)
    v_mfma_f32_16x16x32_bf16 v[96:99], v[224:227], v[184:187], v[96:99]
    s_nop 2
    v_mfma_f32_16x16x32_bf16 v[108:111], v[236:239], v[184:187], v[108:111]
    s_waitcnt lgkmcnt(6)
    s_nop 2
    v_mfma_f32_16x16x32_bf16 v[108:111], v[232:235], v[36:39], v[108:111]
    s_waitcnt lgkmcnt(5)
    ds_write_b128 v2, v[96:99] offset:51328
    v_mfma_f32_16x16x32_bf16 v[108:111], v[228:231], v[40:43], v[108:111]
    s_waitcnt lgkmcnt(5)
    v_mfma_f32_16x16x32_bf16 v[108:111], v[224:227], v[16:19], v[108:111]
    s_nop 2
    v_mfma_f32_16x16x32_bf16 v[112:115], v[240:243], v[184:187], v[112:115]
    s_nop 2
    v_mfma_f32_16x16x32_bf16 v[112:115], v[236:239], v[36:39], v[112:115]
    ds_write_b128 v2, v[108:111] offset:52352
    v_mfma_f32_16x16x32_bf16 v[112:115], v[232:235], v[40:43], v[112:115]
    v_mfma_f32_16x16x32_bf16 v[112:115], v[228:231], v[16:19], v[112:115]
    s_waitcnt lgkmcnt(5)
    v_mfma_f32_16x16x32_bf16 v[112:115], v[224:227], v[20:23], v[112:115]
    s_nop 2
    v_mfma_f32_16x16x32_bf16 v[124:127], v[252:255], v[184:187], v[124:127]
    s_nop 2
    v_mfma_f32_16x16x32_bf16 v[124:127], v[248:251], v[36:39], v[124:127]
    ds_write_b128 v2, v[112:115] offset:53376
    v_mfma_f32_16x16x32_bf16 v[124:127], v[244:247], v[40:43], v[124:127]
    v_mfma_f32_16x16x32_bf16 v[124:127], v[240:243], v[16:19], v[124:127]
    v_mfma_f32_16x16x32_bf16 v[124:127], v[236:239], v[20:23], v[124:127]
    s_waitcnt lgkmcnt(5)
    v_mfma_f32_16x16x32_bf16 v[124:127], v[232:235], v[24:27], v[124:127]
    s_waitcnt lgkmcnt(4)
    v_mfma_f32_16x16x32_bf16 v[124:127], v[228:231], v[28:31], v[124:127]
    s_waitcnt lgkmcnt(3)
    v_mfma_f32_16x16x32_bf16 v[124:127], v[224:227], v[32:35], v[124:127]
    s_nop 2
    v_mfma_f32_16x16x32_bf16 v[116:119], v[212:215], v[128:131], v[116:119]
    s_nop 2
    v_mfma_f32_16x16x32_bf16 v[116:119], v[208:211], v[132:135], v[116:119]
    ds_write_b128 v2, v[124:127] offset:54400
    v_mfma_f32_16x16x32_bf16 v[116:119], v[204:207], v[136:139], v[116:119]
    v_mfma_f32_16x16x32_bf16 v[116:119], v[200:203], v[140:143], v[116:119]
    ds_write_b32 v68, v64 offset:50560
    v_mfma_f32_16x16x32_bf16 v[116:119], v[196:199], v[144:147], v[116:119]
    s_mov_b32 s60, 0
    v_mfma_f32_16x16x32_bf16 v[116:119], v[192:195], v[148:151], v[116:119]
    s_waitcnt vmcnt(0)
    v_cmp_ne_u32 vcc, s52, v6
    v_mfma_f32_16x16x32_bf16 v[116:119], v[244:247], v[184:187], v[116:119]
    s_cbranch_vccnz L_A_c21
L_A_c31:
    v_mfma_f32_16x16x32_bf16 v[116:119], v[240:243], v[36:39], v[116:119]
    v_mfma_f32_16x16x32_bf16 v[116:119], v[236:239], v[40:43], v[116:119]
    v_mfma_f32_16x16x32_bf16 v[116:119], v[232:235], v[16:19], v[116:119]
    ds_read_b32 v9, v69 offset:50560
    v_mfma_f32_16x16x32_bf16 v[116:119], v[228:231], v[20:23], v[116:119]
    ds_read_b128 v[160:163], v7 offset:51328
    v_mfma_f32_16x16x32_bf16 v[116:119], v[224:227], v[24:27], v[116:119]
    ds_read_b128 v[164:167], v7 offset:52352
    v_mfma_f32_16x16x32_bf16 v[120:123], v[216:219], v[128:131], v[120:123]
    ds_read_b128 v[168:171], v7 offset:53376
    v_mfma_f32_16x16x32_bf16 v[120:123], v[212:215], v[132:135], v[120:123]
    ds_read_b128 v[172:175], v7 offset:54400
    v_mfma_f32_16x16x32_bf16 v[120:123], v[208:211], v[136:139], v[120:123]
    v_mfma_f32_16x16x32_bf16 v[120:123], v[204:207], v[140:143], v[120:123]
    v_mfma_f32_16x16x32_bf16 v[120:123], v[200:203], v[144:147], v[120:123]
    s_waitcnt lgkmcnt(4)
    v_cmp_eq_u32 vcc, 0, v9
    v_mfma_f32_16x16x32_bf16 v[120:123], v[196:199], v[148:151], v[120:123]
    s_waitcnt lgkmcnt(0)
    s_cbranch_vccnz L_A_pw1
L_A_pok1:
    v_mfma_f32_16x16x32_bf16 v[120:123], v[192:195], v[152:155], v[120:123]
    v_add_f32 v100, v100, v160
    v_add_f32 v101, v101, v161
    v_mfma_f32_16x16x32_bf16 v[120:123], v[248:251], v[184:187], v[120:123]
    v_add_f32 v102, v102, v162
    v_add_f32 v103, v103, v163
    v_mfma_f32_16x16x32_bf16 v[120:123], v[244:247], v[36:39], v[120:123]
    v_add_f32 v104, v104, v164
    v_add_f32 v105, v105, v165
    v_mfma_f32_16x16x32_bf16 v[120:123], v[240:243], v[40:43], v[120:123]
    v_add_f32 v106, v106, v166
    v_add_f32 v107, v107, v167
    v_mfma_f32_16x16x32_bf16 v[120:123], v[236:239], v[16:19], v[120:123]
    v_add_f32 v168, v116, v168
    v_add_f32 v169, v117, v169
    v_mfma_f32_16x16x32_bf16 v[120:123], v[232:235], v[20:23], v[120:123]
    v_add_f32 v170, v118, v170
    v_add_f32 v171, v119, v171
    v_mfma_f32_16x16x32_bf16 v[120:123], v[228:231], v[24:27], v[120:123]
    v_cvt_pk_bf16_f32 v176, v168, v169
    v_cvt_pk_bf16_f32 v177, v170, v171
    v_mfma_f32_16x16x32_bf16 v[120:123], v[224:227], v[28:31], v[120:123]
    s_nop 2
    v_mfma_f32_16x16x32_bf16 v[100:103], v[196:199], v[128:131], v[100:103]
    s_nop 2
    v_mfma_f32_16x16x32_bf16 v[100:103], v[192:195], v[132:135], v[100:103]
    v_add_f32 v172, v120, v172
    v_add_f32 v173, v121, v173
    v_mfma_f32_16x16x32_bf16 v[100:103], v[228:231], v[184:187], v[100:103]
    v_add_f32 v174, v122, v174
    v_add_f32 v175, v123, v175
    v_mfma_f32_16x16x32_bf16 v[100:103], v[224:227], v[36:39], v[100:103]
    v_cvt_pk_bf16_f32 v178, v172, v173
    v_cvt_pk_bf16_f32 v179, v174, v175
    v_mfma_f32_16x16x32_bf16 v[104:107], v[200:203], v[128:131], v[104:107]
    s_cmp_lg_u32 s60, 0
    v_permlane16_swap_b32 v176, v178
    v_mfma_f32_16x16x32_bf16 v[104:107], v[196:199], v[132:135], v[104:107]
    v_permlane16_swap_b32 v177, v179
    v_mfma_f32_16x16x32_bf16 v[104:107], v[192:195], v[136:139], v[104:107]
    s_cbranch_scc1 L_A_y11
    buffer_store_dwordx4 v[176:179], v75, s[20:23], s45 offen
L_A_y11:
    v_mfma_f32_16x16x32_bf16 v[104:107], v[232:235], v[184:187], v[104:107]
    v_mfma_f32_16x16x32_bf16 v[104:107], v[228:231], v[36:39], v[104:107]
    v_cvt_pk_bf16_f32 v180, v100, v101
    v_cvt_pk_bf16_f32 v181, v102, v103
    v_mfma_f32_16x16x32_bf16 v[104:107], v[224:227], v[40:43], v[104:107]
    s_nop 7
    v_cvt_pk_bf16_f32 v182, v104, v105
    v_cvt_pk_bf16_f32 v183, v106, v107
    s_nop 0
    v_permlane16_swap_b32 v180, v182
    v_permlane16_swap_b32 v181, v183
    s_cbranch_scc1 L_A_yw
    buffer_store_dwordx4 v[180:183], v75, s[20:23], s44 offen
    s_branch L_A_h2
.p2align 12
L_A_w2:
    s_branch L_A_w0
L_A_h2:
L_A_go2:
    buffer_load_dwordx4 v[16:19], v70, s[16:19], s42 offen sc1
    buffer_load_dwordx4 v[20:23], v70, s[16:19], s43 offen sc1
    s_setprio 0
    v_lshlrev_b32 v89, 16, v80
    v_lshlrev_b32 v88, 16, v84
    v_mul_f32 v44, v44, v88
    v_mul_f32 v45, v45, v89
    v_and_b32 v91, 0xffff0000, v80
    v_and_b32 v90, 0xffff0000, v84
    v_mul_f32 v46, v46, v90
    v_mul_f32 v47, v47, v91
    v_lshlrev_b32 v93, 16, v81
    v_lshlrev_b32 v92, 16, v85
    v_mul_f32 v48, v48, v92
    v_mul_f32 v49, v49, v93
    v_and_b32 v95, 0xffff0000, v81
    v_and_b32 v94, 0xffff0000, v85
    v_mul_f32 v50, v50, v94
    v_mul_f32 v51, v51, v95
    v_lshlrev_b32 v77, 16, v82
    v_lshlrev_b32 v76, 16, v86
    v_mul_f32 v52, v52, v76
    v_mul_f32 v53, v53, v77
    v_and_b32 v79, 0xffff0000, v82
    v_and_b32 v78, 0xffff0000, v86
    v_mul_f32 v54, v54, v78
    v_mul_f32 v55, v55, v79
    v_lshlrev_b32 v189, 16, v83
    v_lshlrev_b32 v188, 16, v87
    v_mul_f32 v56, v56, v188
    v_mul_f32 v57, v57, v189
    v_and_b32 v191, 0xffff0000, v83
    v_and_b32 v190, 0xffff0000, v87
    v_mul_f32 v58, v58, v190
    v_mul_f32 v59, v59, v191
    buffer_load_dwordx4 v[16:19], v70, s[16:19], s42 offen sc1
    buffer_load_dwordx4 v[20:23], v70, s[16:19], s43 offen sc1
    s_waitcnt vmcnt(2)
    v_max3_u32 v24, v16, v17, v18
    v_max3_u32 v25, v19, v20, v21
    v_max3_u32 v24, v24, v22, v23
    v_max_u32 v24, v24, v25
    v_cmp_le_u32 vcc, v64, v24
    s_cbranch_vccnz L_A_yretry
L_A_yok:
    ds_write_b128 v74, v[16:19] offset:42240
    ds_write_b128 v74, v[20:23] offset:43280
    ds_write_b32 v68, v64 offset:50576
L_A_ys:
    ds_read_b128 v[36:39], v73 offset:50576
    ds_read2_b32 v[28:29], v10 offset0:0 offset1:32
    ds_read2_b32 v[30:31], v10 offset0:64 offset1:96
    ds_read2_b32 v[32:33], v10 offset0:128 offset1:160
    ds_read2_b32 v[34:35], v10 offset0:192 offset1:224
    s_waitcnt lgkmcnt(4)
    v_min3_u32 v36, v36, v37, v38
    v_min_u32 v36, v36, v39
    v_cmp_eq_u32 vcc, 0, v36
    s_cbranch_vccnz L_A_ys
    s_setprio 2
    s_waitcnt lgkmcnt(3)
    v_and_b32 v208, 0xffff0000, v28
    v_lshlrev_b32 v209, 16, v28
    v_pk_fma_f32 v[44:45], v[88:89], v[208:209], v[44:45]
    v_and_b32 v210, 0xffff0000, v29
    v_lshlrev_b32 v211, 16, v29
    v_pk_fma_f32 v[46:47], v[90:91], v[210:211], v[46:47]
    v_cvt_pk_bf16_f32 v36, v45, v47
    v_cvt_pk_bf16_f32 v40, v44, v46
    s_waitcnt lgkmcnt(2)
    v_and_b32 v212, 0xffff0000, v30
    v_lshlrev_b32 v213, 16, v30
    v_pk_fma_f32 v[48:49], v[92:93], v[212:213], v[48:49]
    v_and_b32 v214, 0xffff0000, v31
    v_lshlrev_b32 v215, 16, v31
    v_pk_fma_f32 v[50:51], v[94:95], v[214:215], v[50:51]
    v_cvt_pk_bf16_f32 v37, v49, v51
    v_cvt_pk_bf16_f32 v41, v48, v50
    s_waitcnt lgkmcnt(1)
    v_and_b32 v216, 0xffff0000, v32
    v_lshlrev_b32 v217, 16, v32
    v_pk_fma_f32 v[52:53], v[76:77], v[216:217], v[52:53]
    v_and_b32 v218, 0xffff0000, v33
    v_lshlrev_b32 v219, 16, v33
    v_pk_fma_f32 v[54:55], v[78:79], v[218:219], v[54:55]
    v_cvt_pk_bf16_f32 v38, v53, v55
    v_cvt_pk_bf16_f32 v42, v52, v54
    s_waitcnt lgkmcnt(0)
    v_and_b32 v220, 0xffff0000, v34
    v_lshlrev_b32 v221, 16, v34
    v_pk_fma_f32 v[56:57], v[188:189], v[220:221], v[56:57]
    v_and_b32 v222, 0xffff0000, v35
    v_lshlrev_b32 v223, 16, v35
    v_pk_fma_f32 v[58:59], v[190:191], v[222:223], v[58:59]
    v_cvt_pk_bf16_f32 v39, v57, v59
    v_cvt_pk_bf16_f32 v43, v56, v58
    global_store_dwordx4 v72, v[36:39], s[20:21] nt
    global_store_dwordx4 v72, v[40:43], s[20:21] offset:2048 nt
    s_endpgm
L_A_c20:
    buffer_load_dword v6, v5, s[28:31], s46 offen offset:512 sc1
    s_mov_b32 s60, 1
    s_branch L_A_c30
L_A_c21:
    buffer_load_dword v6, v5, s[28:31], s46 offen offset:512 sc1
    s_mov_b32 s60, 1
    s_branch L_A_c31
L_A_yw:
    s_cmp_lg_u32 s59, 0
    s_cbranch_scc1 L_A_slow2
    s_waitcnt vmcnt(0)
    v_cmp_ne_u32 vcc, s52, v6
    s_cbranch_vccz L_A_yst
    s_mov_b32 s60, 0
L_A_poll2:
    buffer_load_dword v6, v5, s[28:31], s46 offen offset:512 sc1
    s_add_u32 s60, s60, 1
    s_waitcnt vmcnt(0)
    v_cmp_ne_u32 vcc, s52, v6
    s_cbranch_vccz L_A_yst
    s_cmp_lt_u32 s60, 524288
    s_cbranch_scc1 L_A_poll2
    s_branch L_A_yst
L_A_yst:
    buffer_store_dwordx4 v[176:179], v75, s[20:23], s45 offen
    buffer_store_dwordx4 v[180:183], v75, s[20:23], s44 offen
    s_branch L_A_h2
L_A_yretry:
    s_mov_b32 s60, 0
L_A_yretrya:
    s_mov_b64 exec, vcc
    buffer_load_dwordx4 v[16:19], v70, s[16:19], s42 offen sc1
    buffer_load_dwordx4 v[20:23], v70, s[16:19], s43 offen sc1
    s_add_u32 s60, s60, 1
    s_and_b32 s61, s60, 31
    s_waitcnt vmcnt(2)
    v_max3_u32 v24, v16, v17, v18
    v_max3_u32 v25, v19, v20, v21
    v_max3_u32 v24, v24, v22, v23
    v_max_u32 v24, v24, v25
    v_cmp_le_u32 vcc, v64, v24
    s_mov_b64 exec, -1
    s_cbranch_vccz L_A_yok
    s_cbranch_scc1 L_A_yretrya
    v_cmp_eq_u32 s[32:33], v64, v16
    v_cmp_eq_u32 vcc, v64, v17
    s_or_b64 s[32:33], s[32:33], vcc
    v_cmp_eq_u32 vcc, v64, v18
    s_or_b64 s[32:33], s[32:33], vcc
    v_cmp_eq_u32 vcc, v64, v19
    s_or_b64 s[32:33], s[32:33], vcc
    v_cmp_eq_u32 vcc, v64, v20
    s_or_b64 s[32:33], s[32:33], vcc
    v_cmp_eq_u32 vcc, v64, v21
    s_or_b64 s[32:33], s[32:33], vcc
    v_cmp_eq_u32 vcc, v64, v22
    s_or_b64 s[32:33], s[32:33], vcc
    v_cmp_eq_u32 vcc, v64, v23
    s_or_b64 s[32:33], s[32:33], vcc
    s_cbranch_scc0 L_A_yok
    s_mov_b64 vcc, s[32:33]
    s_cmp_lt_u32 s60, 524288
    s_cbranch_scc1 L_A_yretrya
    s_branch L_A_yok
L_A_pw0:
    ds_read_b32 v9, v69 offset:50560
    ds_read_b128 v[160:163], v7 offset:51328
    ds_read_b128 v[164:167], v7 offset:52352
    ds_read_b128 v[168:171], v7 offset:53376
    ds_read_b128 v[172:175], v7 offset:54400
    s_waitcnt lgkmcnt(0)
    v_cmp_eq_u32 vcc, 0, v9
    s_cbranch_vccnz L_A_pw0
    s_branch L_A_pok0
L_A_pw1:
    ds_read_b32 v9, v69 offset:50560
    ds_read_b128 v[160:163], v7 offset:51328
    ds_read_b128 v[164:167], v7 offset:52352
    ds_read_b128 v[168:171], v7 offset:53376
    ds_read_b128 v[172:175], v7 offset:54400
    s_waitcnt lgkmcnt(0)
    v_cmp_eq_u32 vcc, 0, v9
    s_cbranch_vccnz L_A_pw1
    s_branch L_A_pok1
L_A_slow2:
    s_add_u32 s16, s16, 1024
    s_addc_u32 s17, s17, 0
    s_sub_u32 s18, s18, 1024
    buffer_store_dwordx4 v[176:179], v75, s[16:19], s45 offen sc1
    buffer_store_dwordx4 v[180:183], v75, s[16:19], s44 offen sc1
    s_lshl_b32 s56, s55, 8
    s_lshl3_add_u32 s56, s35, s56
    s_lshl2_add_u32 s56, s54, s56
    v_mov_b32 v4, s56
    s_lshr_b32 s56, s35, 2
    s_lshr_b32 s60, s35, 3
    s_xor_b32 s56, s56, s60
    s_and_b32 s56, s56, 1
    s_lshl_b32 s56, s56, 8
    s_lshl_b32 s60, s36, 6
    s_add_u32 s56, s56, s60
    v_and_b32 v5, 15, v14
    v_lshl_add_u32 v5, v5, 2, s56
    v_mov_b32 v9, s41
    s_waitcnt vmcnt(0)
    buffer_store_dword v9, v4, s[28:31], s47 offen offset:512 sc1
    s_mov_b32 s60, 0
L_A_poll2s:
    buffer_load_dword v6, v5, s[28:31], s47 offen offset:512 sc1
    s_add_u32 s60, s60, 1
    s_waitcnt vmcnt(0)
    v_cmp_ne_u32 vcc, s41, v6
    s_cbranch_vccz L_A_h2
    s_cmp_lt_u32 s60, 524288
    s_cbranch_scc1 L_A_poll2s
    s_branch L_A_h2
.p2align 12
L_B:
    s_add_u32 s28, s28, 255852544
    s_addc_u32 s29, s29, 0
    s_mov_b32 s30, 12582912
    s_mov_b32 s31, 0x20000
    s_lshl_b32 s50, s37, 5
    s_add_u32 s43, s43, s50
    s_lshl_b32 s50, s36, 8
    s_add_u32 s50, s50, s43
    s_lshl_b32 s57, s50, 5
    s_add_u32 s57, s57, 6029312
    s_lshl_b32 s58, s50, 5
    s_add_u32 s58, s58, 5832704
    v_and_b32 v5, 15, v14
    v_lshrrev_b32 v2, 4, v14
    v_lshl_add_u32 v8, v1, 4, v5
    v_mov_b32 v1, v5
    v_lshrrev_b32 v9, 1, v8
    v_cmp_eq_u32 vcc, 1, v8
    v_and_b32 v10, 1, v8
    v_bfe_i32 v12, v8, 1, 1
    v_cndmask_b32 v9, v9, 32, vcc
    v_cndmask_b32 v10, v10, 0, vcc
    v_and_b32 v12, 0x80008000, v12
    v_mul_u32_u24 v11, v9, v2
    v_lshl_add_u32 v11, v10, 2, v11
    v_cvt_f32_u32 v9, v9
    v_cvt_f32_u32 v11, v11
    v_mul_f32 v10, 0x3e800000, v9
    v_mul_f32 v9, 0x3c800000, v9
    v_mul_f32 v128, 0x3d800000, v11
    v_add_f32 v129, v9, v128
    v_add_f32 v130, v9, v129
    v_add_f32 v131, v9, v130
    v_add_f32 v132, v10, v128
    v_add_f32 v133, v10, v129
    v_add_f32 v134, v10, v130
    v_add_f32 v135, v10, v131
    v_cos_f32 v128, v128
    v_cos_f32 v129, v129
    v_cos_f32 v130, v130
    v_cos_f32 v131, v131
    v_cos_f32 v132, v132
    v_cos_f32 v133, v133
    v_cos_f32 v134, v134
    v_cos_f32 v135, v135
    v_cvt_pk_bf16_f32 v160, v128, v129
    v_cvt_pk_bf16_f32 v161, v130, v131
    v_cvt_pk_bf16_f32 v162, v132, v133
    v_cvt_pk_bf16_f32 v163, v134, v135
    v_xor_b32 v164, v12, v160
    v_xor_b32 v165, v12, v161
    v_xor_b32 v166, v12, v162
    v_xor_b32 v167, v12, v163
    v_and_b32 v3, 60, v14
    v_and_b32 v4, 3, v14
    v_lshl_add_u32 v3, v3, 1, v4
    v_and_b32 v4, 1, v2
    v_lshl_add_u32 v3, v4, 2, v3
    s_mov_b32 s45, 77184
    v_lshl_add_u32 v77, v3, 3, s45
    v_xor_b32 v78, 32, v77
    s_lshl_b32 s44, s34, 18
    s_lshl_b32 s45, s35, 13
    s_add_u32 s44, s44, s45
    s_lshr_b32 s45, s36, 1
    s_lshl_b32 s46, s45, 12
    s_add_u32 s44, s44, s46
    v_and_b32 v3, 127, v0
    v_lshl_add_u32 v71, v3, 3, s44
    v_cmp_eq_u32 s[22:23], 0, v3
    v_add_u32 v70, 8, v71
    s_mul_i32 s45, s45, 16512
    v_cndmask_b32 v70, v71, v70, s[22:23]
    v_lshl_add_u32 v72, v3, 5, s45
    v_lshrrev_b32 v3, 5, v14
    v_and_b32 v4, 31, v14
    v_mul_u32_u24 v7, 147968, v3
    v_lshl_add_u32 v7, v4, 2, v7
    v_lshlrev_b32 v79, 3, v2
    v_lshl_add_u32 v79, v1, 5, v79
    s_lshl_b32 s44, s43, 7
    s_mul_i32 s45, s36, 295936
    s_add_u32 s44, s44, s45
    s_add_u32 s44, s44, 2097152
    s_lshr_b32 s47, s35, 3
    s_lshl2_add_u32 s46, s34, s47
    s_and_b32 s47, s35, 3
    s_bfe_u32 s48, s35, 0x10002
    s_sub_u32 s49, 64, s46
    s_cmp_eq_u32 s46, 0
    s_cselect_b32 s49, 32, s49
    s_cmp_eq_u32 s48, 0
    s_cselect_b32 s49, s46, s49
    s_lshl_b32 s47, s47, 9
    s_add_u32 s49, s49, s47
    v_mul_u32_u24 v6, 7, v3
    v_lshlrev_b32 v3, 2, v2
    v_sub_u32 v6, v3, v6
    v_cvt_f32_u32 v3, v3
    v_cvt_f32_u32 v62, v6
    v_cvt_f32_u32 v4, v1
    s_waitcnt lgkmcnt(0)
    s_load_dword s59, s[28:29], s58 glc
    s_lshl_b32 s51, s36, 2
    v_mov_b32 v8, s51
    v_mov_b32 v13, 0
    v_mov_b32 v12, 1
    s_waitcnt vmcnt(0)
    s_barrier
    ds_read_b64_tr_b16 v[192:193], v78 offset:4096
    ds_read_b64_tr_b16 v[194:195], v78 offset:5120
    ds_read_b64_tr_b16 v[196:197], v78 offset:6144
    ds_read_b64_tr_b16 v[198:199], v78 offset:7168
    ds_read_b64_tr_b16 v[200:201], v77 offset:4096
    ds_read_b64_tr_b16 v[202:203], v77 offset:5120
    ds_read_b64_tr_b16 v[204:205], v77 offset:6144
    ds_read_b64_tr_b16 v[206:207], v77 offset:7168
    ds_read_b64_tr_b16 v[208:209], v77 offset:0
    ds_read_b64_tr_b16 v[210:211], v77 offset:1024
    ds_read_b64_tr_b16 v[212:213], v77 offset:2048
    ds_read_b64_tr_b16 v[214:215], v77 offset:3072
    ds_read_b64_tr_b16 v[216:217], v78 offset:0
    ds_read_b64_tr_b16 v[218:219], v78 offset:1024
    ds_read_b64_tr_b16 v[220:221], v78 offset:2048
    ds_read_b64_tr_b16 v[222:223], v78 offset:3072
    global_load_dwordx4 v[96:99], v70, s[12:13] offset:-8 nt
    global_load_dwordx4 v[100:103], v71, s[12:13] offset:1016 nt
    global_load_dwordx4 v[104:107], v71, s[12:13] offset:2040 nt
    global_load_dwordx4 v[108:111], v71, s[12:13] offset:3064 nt
    s_waitcnt lgkmcnt(14)
    v_mfma_f32_16x16x32_bf16 v[224:227], v[160:163], v[192:195], 0
    s_waitcnt lgkmcnt(12)
    v_mfma_f32_16x16x32_bf16 v[224:227], v[164:167], v[196:199], v[224:227]
    s_waitcnt lgkmcnt(10)
    v_mfma_f32_16x16x32_bf16 v[228:231], v[160:163], v[200:203], 0
    s_waitcnt lgkmcnt(8)
    v_mfma_f32_16x16x32_bf16 v[228:231], v[164:167], v[204:207], v[228:231]
    s_waitcnt lgkmcnt(6)
    v_mfma_f32_16x16x32_bf16 v[232:235], v[160:163], v[208:211], 0
    s_waitcnt lgkmcnt(4)
    v_mfma_f32_16x16x32_bf16 v[232:235], v[164:167], v[212:215], v[232:235]
    s_waitcnt lgkmcnt(2)
    v_mfma_f32_16x16x32_bf16 v[236:239], v[160:163], v[216:219], 0
    s_waitcnt lgkmcnt(0)
    v_mfma_f32_16x16x32_bf16 v[236:239], v[164:167], v[220:223], v[236:239]
    v_mov_b32_dpp v128, v224 row_mirror row_mask:0xf bank_mask:0xf
    v_mov_b32_dpp v129, v225 row_mirror row_mask:0xf bank_mask:0xf
    v_mov_b32_dpp v130, v226 row_mirror row_mask:0xf bank_mask:0xf
    v_mov_b32_dpp v131, v227 row_mirror row_mask:0xf bank_mask:0xf
    v_mov_b32_dpp v132, v228 row_mirror row_mask:0xf bank_mask:0xf
    v_mov_b32_dpp v133, v229 row_mirror row_mask:0xf bank_mask:0xf
    v_mov_b32_dpp v134, v230 row_mirror row_mask:0xf bank_mask:0xf
    v_mov_b32_dpp v135, v231 row_mirror row_mask:0xf bank_mask:0xf
    v_cvt_pk_bf16_f32 v244, v228, v229
    v_cvt_pk_bf16_f32 v245, v230, v231
    v_add_f32_dpp v232, v128, v232 row_shr:1 row_mask:0xf bank_mask:0xf
    v_add_f32_dpp v233, v129, v233 row_shr:1 row_mask:0xf bank_mask:0xf
    v_add_f32_dpp v234, v130, v234 row_shr:1 row_mask:0xf bank_mask:0xf
    v_add_f32_dpp v235, v131, v235 row_shr:1 row_mask:0xf bank_mask:0xf
    v_add_f32_dpp v236, v132, v236 row_shr:1 row_mask:0xf bank_mask:0xf
    v_add_f32_dpp v237, v133, v237 row_shr:1 row_mask:0xf bank_mask:0xf
    v_add_f32_dpp v238, v134, v238 row_shr:1 row_mask:0xf bank_mask:0xf
    v_add_f32_dpp v239, v135, v239 row_shr:1 row_mask:0xf bank_mask:0xf
    v_add_f32_dpp v236, v128, v236 row_shl:15 row_mask:0xf bank_mask:0xf
    v_add_f32_dpp v237, v129, v237 row_shl:15 row_mask:0xf bank_mask:0xf
    v_add_f32_dpp v238, v130, v238 row_shl:15 row_mask:0xf bank_mask:0xf
    v_add_f32_dpp v239, v131, v239 row_shl:15 row_mask:0xf bank_mask:0xf
    v_cvt_pk_bf16_f32 v240, v232, v233
    v_cvt_pk_bf16_f32 v241, v234, v235
    v_cvt_pk_bf16_f32 v242, v236, v237
    v_cvt_pk_bf16_f32 v243, v238, v239
    s_add_u32 s41, s41, 2654435760
    s_add_u32 s45, s44, 73984
    v_permlane16_swap_b32 v240, v242
    buffer_store_dword v240, v7, s[28:31], s44 offen sc1
    buffer_store_dword v242, v7, s[28:31], s45 offen sc1
    v_permlane16_swap_b32 v241, v243
    s_add_u32 s44, s44, 36992
    s_add_u32 s45, s45, 36992
    buffer_store_dword v241, v7, s[28:31], s44 offen sc1
    buffer_store_dword v243, v7, s[28:31], s45 offen sc1
    s_mov_b32 exec_lo, 65537
    s_mov_b32 exec_hi, exec_lo
    buffer_store_dwordx2 v[244:245], v79, s[28:31], s57 offen sc1
    s_mov_b64 exec, -1
    s_mov_b32 s59, s41
    v_mul_f32 v5, 0x3d800000, v4
    v_mul_f32 v6, v5, v62
    v_fmamk_f32 v128, v5, 0x00000000, v6
    v_fmamk_f32 v129, v5, 0x3f800000, v6
    v_fmamk_f32 v130, v5, 0x40000000, v6
    v_fmamk_f32 v131, v5, 0x40400000, v6
    v_sin_f32 v132, v128
    v_cos_f32 v128, v128
    v_sin_f32 v133, v129
    v_cos_f32 v129, v129
    v_sin_f32 v134, v130
    v_cos_f32 v130, v130
    v_sin_f32 v135, v131
    v_cos_f32 v131, v131
    v_cvt_pk_bf16_f32 v20, v128, v132
    v_cvt_pk_bf16_f32 v24, -v132, v128
    v_cvt_pk_bf16_f32 v21, v129, v133
    v_cvt_pk_bf16_f32 v25, -v133, v129
    v_cvt_pk_bf16_f32 v22, v130, v134
    v_cvt_pk_bf16_f32 v26, -v134, v130
    v_cvt_pk_bf16_f32 v23, v131, v135
    v_cvt_pk_bf16_f32 v27, -v135, v131
    v_mul_f32 v5, 0x3b000000, v4
    v_mul_f32 v6, v5, v3
    v_fmamk_f32 v44, v5, 0x00000000, v6
    v_fmamk_f32 v45, v5, 0x3f800000, v6
    v_fmamk_f32 v46, v5, 0x40000000, v6
    v_fmamk_f32 v47, v5, 0x40400000, v6
    v_fmamk_f32 v48, v5, 0x41800000, v6
    v_fmamk_f32 v49, v5, 0x41880000, v6
    v_fmamk_f32 v50, v5, 0x41900000, v6
    v_fmamk_f32 v51, v5, 0x41980000, v6
    v_sin_f32 v52, v44
    v_cos_f32 v44, v44
    v_sin_f32 v53, v45
    v_cos_f32 v45, v45
    v_sin_f32 v54, v46
    v_cos_f32 v46, v46
    v_sin_f32 v55, v47
    v_cos_f32 v47, v47
    v_sin_f32 v56, v48
    v_cos_f32 v48, v48
    v_sin_f32 v57, v49
    v_cos_f32 v49, v49
    v_sin_f32 v58, v50
    v_cos_f32 v50, v50
    v_sin_f32 v59, v51
    v_cos_f32 v51, v51
    v_mul_f32 v5, 0x3d000000, v4
    v_mul_f32 v6, v5, v3
    v_fmamk_f32 v128, v5, 0x00000000, v6
    v_fmamk_f32 v129, v5, 0x3f800000, v6
    v_fmamk_f32 v130, v5, 0x40000000, v6
    v_fmamk_f32 v131, v5, 0x40400000, v6
    v_sin_f32 v132, v128
    v_cos_f32 v128, v128
    v_sin_f32 v133, v129
    v_cos_f32 v129, v129
    v_sin_f32 v134, v130
    v_cos_f32 v130, v130
    v_sin_f32 v135, v131
    v_cos_f32 v131, v131
    v_cvt_pk_bf16_f32 v28, v128, v132
    v_cvt_pk_bf16_f32 v29, v129, v133
    v_cvt_pk_bf16_f32 v30, v130, v134
    v_cvt_pk_bf16_f32 v31, v131, v135
    v_mov_b32 v36, v28
    v_xor_b32 v37, 0x80008000, v29
    v_mov_b32 v38, v30
    v_xor_b32 v39, 0x80008000, v31
    v_fmamk_f32 v128, v5, 0x41800000, v6
    v_fmamk_f32 v129, v5, 0x41880000, v6
    v_fmamk_f32 v130, v5, 0x41900000, v6
    v_fmamk_f32 v131, v5, 0x41980000, v6
    v_sin_f32 v132, v128
    v_cos_f32 v128, v128
    v_sin_f32 v133, v129
    v_cos_f32 v129, v129
    v_sin_f32 v134, v130
    v_cos_f32 v130, v130
    v_sin_f32 v135, v131
    v_cos_f32 v131, v131
    v_cvt_pk_bf16_f32 v32, v128, v132
    v_cvt_pk_bf16_f32 v33, v129, v133
    v_cvt_pk_bf16_f32 v34, v130, v134
    v_cvt_pk_bf16_f32 v35, v131, v135
    v_mov_b32 v40, v32
    v_xor_b32 v41, 0x80008000, v33
    v_mov_b32 v42, v34
    v_xor_b32 v43, 0x80008000, v35
    s_waitcnt vmcnt(8)
    v_cndmask_b32 v99, v99, v97, s[22:23]
    v_cndmask_b32 v98, v98, v96, s[22:23]
    v_cndmask_b32 v97, v97, 0, s[22:23]
    v_cndmask_b32 v96, v96, 0, s[22:23]
    v_alignbit_b32 v112, v97, v96, 16
    v_alignbit_b32 v113, v98, v97, 16
    v_mov_b32 v114, v97
    v_mov_b32 v115, v98
    v_mov_b32 v96, v113
    v_alignbit_b32 v97, v99, v98, 16
    ds_write_b128 v72, v[112:115] offset:128
    ds_write_b128 v72, v[96:99] offset:144
    s_waitcnt vmcnt(7)
    v_alignbit_b32 v116, v101, v100, 16
    v_alignbit_b32 v117, v102, v101, 16
    v_mov_b32 v118, v101
    v_mov_b32 v119, v102
    v_mov_b32 v100, v117
    v_alignbit_b32 v101, v103, v102, 16
    ds_write_b128 v72, v[116:119] offset:4224
    ds_write_b128 v72, v[100:103] offset:4240
    s_waitcnt vmcnt(6)
    v_alignbit_b32 v120, v105, v104, 16
    v_alignbit_b32 v121, v106, v105, 16
    v_mov_b32 v122, v105
    v_mov_b32 v123, v106
    v_mov_b32 v104, v121
    v_alignbit_b32 v105, v107, v106, 16
    ds_write_b128 v72, v[120:123] offset:8320
    ds_write_b128 v72, v[104:107] offset:8336
    s_waitcnt vmcnt(5)
    v_alignbit_b32 v124, v109, v108, 16
    v_alignbit_b32 v125, v110, v109, 16
    v_mov_b32 v126, v109
    v_mov_b32 v127, v110
    v_mov_b32 v108, v125
    v_alignbit_b32 v109, v111, v110, 16
    ds_write_b128 v72, v[124:127] offset:12416
    ds_write_b128 v72, v[108:111] offset:12432
    ds_write_b32 v8, v12 offset:50624
    s_waitcnt vmcnt(0)
    s_atomic_swap s59, s[28:29], s58
    s_lshr_b32 s50, s46, 3
    s_lshl_b32 s50, s50, 8
    v_add_u32 v9, s50, v0
    v_lshlrev_b32 v252, 5, v9
    v_lshlrev_b32 v9, 5, v9
    s_mov_b32 s52, 5832704
    s_and_b32 s50, s46, 7
    s_lshl2_add_u32 s55, s50, 6029312
    v_lshrrev_b32 v5, 1, v1
    v_lshl_add_u32 v5, v5, 6, s49
    v_cvt_f32_u32 v5, v5
    v_mul_f32 v5, 0x3a000000, v5
    v_and_b32 v6, 1, v1
    v_cvt_f32_u32 v6, v6
    v_mul_f32 v6, 0x3e800000, v6
    v_fmac_f32 v6, v5, v3
    s_cmp_eq_u32 s48, 0
    s_mov_b32 s50, 0x3e800000
    s_cselect_b32 s50, 0xbe800000, s50
    s_mov_b32 s51, 0xffff0000
    s_cselect_b32 s51, 0x0000ffff, s51
    s_cmp_eq_u32 s46, 0
    s_cselect_b32 s50, 0, s50
    s_cselect_b32 s51, s51, -1
    v_fmamk_f32 v128, v5, 0x00000000, v6
    v_add_f32 v129, s50, v128
    v_fmamk_f32 v130, v5, 0x3f800000, v6
    v_add_f32 v131, s50, v130
    v_fmamk_f32 v132, v5, 0x40000000, v6
    v_add_f32 v133, s50, v132
    v_fmamk_f32 v134, v5, 0x40400000, v6
    v_add_f32 v135, s50, v134
    v_cos_f32 v128, v128
    v_cos_f32 v129, v129
    v_cos_f32 v130, v130
    v_cos_f32 v131, v131
    v_cos_f32 v132, v132
    v_cos_f32 v133, v133
    v_cos_f32 v134, v134
    v_cos_f32 v135, v135
    v_cvt_pk_bf16_f32 v152, v128, v129
    v_cvt_pk_bf16_f32 v153, v130, v131
    v_cvt_pk_bf16_f32 v154, v132, v133
    v_cvt_pk_bf16_f32 v155, v134, v135
    v_and_b32 v152, s51, v152
    v_and_b32 v153, s51, v153
    v_and_b32 v154, s51, v154
    v_and_b32 v155, s51, v155
    v_fmamk_f32 v128, v5, 0x41800000, v6
    v_add_f32 v129, s50, v128
    v_fmamk_f32 v130, v5, 0x41880000, v6
    v_add_f32 v131, s50, v130
    v_fmamk_f32 v132, v5, 0x41900000, v6
    v_add_f32 v133, s50, v132
    v_fmamk_f32 v134, v5, 0x41980000, v6
    v_add_f32 v135, s50, v134
    v_cos_f32 v128, v128
    v_cos_f32 v129, v129
    v_cos_f32 v130, v130
    v_cos_f32 v131, v131
    v_cos_f32 v132, v132
    v_cos_f32 v133, v133
    v_cos_f32 v134, v134
    v_cos_f32 v135, v135
    v_cvt_pk_bf16_f32 v156, v128, v129
    v_cvt_pk_bf16_f32 v157, v130, v131
    v_cvt_pk_bf16_f32 v158, v132, v133
    v_cvt_pk_bf16_f32 v159, v134, v135
    v_and_b32 v156, s51, v156
    v_and_b32 v157, s51, v157
    v_and_b32 v158, s51, v158
    v_and_b32 v159, s51, v159
L_B_gs:
    s_sleep 1
    ds_read_b128 v[64:67], v13 offset:50640
    s_waitcnt lgkmcnt(0)
    v_min3_u32 v64, v64, v65, v66
    v_min_u32 v64, v64, v67
    v_cmp_eq_u32 vcc, 0, v64
    s_cbranch_vccnz L_B_gs
    v_and_b32 v3, 7, v1
    v_lshrrev_b32 v4, 3, v1
    v_lshlrev_b32 v5, 4, v3
    v_lshl_add_u32 v5, v2, 9, v5
    v_lshl_add_u32 v63, v4, 12, v5
    s_mul_i32 s50, s46, 36992
    s_lshl_b32 s51, s36, 13
    s_add_u32 s50, s50, s51
    s_add_u32 s47, s50, 2097152
    s_lshr_b32 s50, s36, 1
    v_xor_b32 v6, s50, v3
    v_lshl_add_u32 v6, v3, 3, v6
    v_lshl_add_u32 v6, v6, 2, v4
    v_lshl_add_u32 v6, v2, 9, v6
    s_and_b32 s50, s36, 1
    s_lshl3_add_u32 s50, s50, 67712
    v_lshl_add_u32 v16, v6, 2, s50
    v_xor_b32 v17, 32, v16
    v_xor_b32 v18, 64, v16
    v_xor_b32 v19, 0x60, v16
    v_and_b32 v5, 1, v1
    v_lshl_add_u32 v6, v5, 3, v2
    s_lshl_b32 s50, s36, 8
    s_add_u32 s50, s50, 76160
    s_mov_b32 m0, s50
    v_lshl_add_u32 v60, v6, 4, s50
    v_lshl_add_u32 v6, v2, 4, v5
    s_lshl3_add_u32 s50, s36, 75904
    v_lshl_add_u32 v61, v6, 2, s50
    v_lshrrev_b32 v3, 2, v1
    v_and_b32 v4, 3, v1
    v_lshl_add_u32 v4, v4, 1, v2
    v_xor_b32 v4, v4, v3
    v_lshl_add_u32 v4, v3, 3, v4
    s_lshl_b32 s51, s36, 11
    s_add_u32 s51, s51, 67712
    v_lshl_add_u32 v248, v4, 4, s51
    v_xor_b32 v249, 64, v248
    v_add_u32 v249, 0x200, v249
    v_add_u32 v250, 0x400, v248
    v_add_u32 v251, 0x400, v249
    s_mov_b32 exec_lo, 0
    v_mov_b32 v248, 33024
    v_mov_b32 v249, v248
    v_mov_b32 v250, v248
    v_mov_b32 v251, v248
    s_mov_b32 exec_hi, 0x00010001
    s_lshl_b32 s51, s36, 6
    s_add_u32 s51, s51, 75872
    v_lshl_add_u32 v248, v2, 4, s51
    v_add_u32 v250, 32, v248
    s_mov_b64 exec, -1
    v_and_b32 v11, 1, v2
    v_lshlrev_b32 v11, 9, v11
    v_lshl_add_u32 v11, v1, 5, v11
    v_lshrrev_b32 v3, 1, v2
    v_lshl_add_u32 v11, v3, 4, v11
    s_lshl_b32 s53, s36, 7
    s_add_u32 s53, s53, s49
    s_lshl_b32 s53, s53, 11
    s_add_u32 s54, s53, 0x20000
    s_mov_b64 s[24:25], s[20:21]
    s_mov_b32 s26, 0x400000
    s_mov_b32 s27, 0x20000
    buffer_load_dword v10, v9, s[28:31], s52 offen sc1
    s_waitcnt vmcnt(0)
    v_cmp_ne_u32 vcc, s41, v10
    s_cbranch_vccnz L_B_poll
L_B_go:
    buffer_load_dword v252, s[28:31], s55 offen sc1 lds
    buffer_load_dwordx4 v[64:67], v63, s[28:31], s47 offen offset:0 sc1
    buffer_load_dwordx4 v[68:71], v63, s[28:31], s47 offen offset:128 sc1
    buffer_load_dwordx4 v[72:75], v63, s[28:31], s47 offen offset:256 sc1
    buffer_load_dwordx4 v[76:79], v63, s[28:31], s47 offen offset:384 sc1
    buffer_load_dwordx4 v[80:83], v63, s[28:31], s47 offen offset:2048 sc1
    buffer_load_dwordx4 v[84:87], v63, s[28:31], s47 offen offset:2176 sc1
    buffer_load_dwordx4 v[88:91], v63, s[28:31], s47 offen offset:2304 sc1
    buffer_load_dwordx4 v[92:95], v63, s[28:31], s47 offen offset:2432 sc1
    s_waitcnt vmcnt(4)
    ds_read_b128 v[116:119], v60
    ds_read_b128 v[120:123], v60 offset:64
    v_swap_b32 v65, v68
    v_swap_b32 v66, v72
    v_swap_b32 v70, v73
    v_swap_b32 v67, v76
    v_swap_b32 v71, v77
    v_swap_b32 v75, v78
    s_waitcnt vmcnt(2)
    v_swap_b32 v81, v84
    s_waitcnt vmcnt(1)
    v_swap_b32 v82, v88
    v_swap_b32 v86, v89
    s_waitcnt vmcnt(0)
    v_swap_b32 v83, v92
    v_swap_b32 v87, v93
    v_swap_b32 v91, v94
    s_waitcnt lgkmcnt(0)
    v_mfma_f32_16x16x32_bf16 v[112:115], v[152:155], v[116:119], 0
    v_mfma_f32_16x16x32_bf16 v[112:115], v[156:159], v[120:123], v[112:115]
    v_mfma_f32_16x16x32_bf16 v[96:99], v[152:155], v[64:67], 0
    v_mfma_f32_16x16x32_bf16 v[96:99], v[156:159], v[80:83], v[96:99]
    v_mfma_f32_16x16x32_bf16 v[100:103], v[152:155], v[68:71], 0
    v_mfma_f32_16x16x32_bf16 v[100:103], v[156:159], v[84:87], v[100:103]
    v_mfma_f32_16x16x32_bf16 v[104:107], v[152:155], v[72:75], 0
    v_mfma_f32_16x16x32_bf16 v[104:107], v[156:159], v[88:91], v[104:107]
    v_mfma_f32_16x16x32_bf16 v[108:111], v[152:155], v[76:79], 0
    v_mfma_f32_16x16x32_bf16 v[108:111], v[156:159], v[92:95], v[108:111]
    v_cvt_pk_bf16_f32 v136, v112, v113
    v_cvt_pk_bf16_f32 v137, v114, v115
    ds_write2_b32 v61, v136, v137 offset0:0 offset1:8
    v_cvt_pk_bf16_f32 v128, v96, v97
    v_cvt_pk_bf16_f32 v129, v98, v99
    ds_write2st64_b32 v16, v128, v129 offset0:0 offset1:4
    v_cvt_pk_bf16_f32 v130, v100, v101
    v_cvt_pk_bf16_f32 v131, v102, v103
    ds_write2st64_b32 v17, v130, v131 offset0:0 offset1:4
    v_cvt_pk_bf16_f32 v132, v104, v105
    v_cvt_pk_bf16_f32 v133, v106, v107
    ds_write2st64_b32 v18, v132, v133 offset0:0 offset1:4
    v_cvt_pk_bf16_f32 v134, v108, v109
    v_cvt_pk_bf16_f32 v135, v110, v111
    ds_write2st64_b32 v19, v134, v135 offset0:0 offset1:4
    ds_write_b32 v8, v12 offset:50592
L_B_vs:
    ds_read_b128 v[64:67], v13 offset:50592
    s_waitcnt lgkmcnt(0)
    v_min3_u32 v64, v64, v65, v66
    v_min_u32 v64, v64, v67
    v_cmp_eq_u32 vcc, 0, v64
    s_cbranch_vccnz L_B_vs
    ds_read_b128 v[80:83], v248
    ds_read_b128 v[84:87], v249
    ds_read_b128 v[88:91], v250
    ds_read_b128 v[92:95], v251
    s_waitcnt lgkmcnt(3)
    v_mfma_f32_16x16x32_bf16 v[96:99], v[80:83], v[20:23], 0
    v_mfma_f32_16x16x32_bf16 v[100:103], v[80:83], v[24:27], 0
    s_waitcnt lgkmcnt(2)
    v_mfma_f32_16x16x32_bf16 v[104:107], v[84:87], v[20:23], 0
    v_mfma_f32_16x16x32_bf16 v[108:111], v[84:87], v[24:27], 0
    s_waitcnt lgkmcnt(1)
    v_mfma_f32_16x16x32_bf16 v[112:115], v[88:91], v[20:23], 0
    v_mfma_f32_16x16x32_bf16 v[116:119], v[88:91], v[24:27], 0
    s_waitcnt lgkmcnt(0)
    v_mfma_f32_16x16x32_bf16 v[120:123], v[92:95], v[20:23], 0
    v_mfma_f32_16x16x32_bf16 v[124:127], v[92:95], v[24:27], 0
    v_pk_mul_f32 v[160:161], v[44:45], v[96:97]
    v_pk_mul_f32 v[162:163], v[46:47], v[98:99]
    v_pk_mul_f32 v[164:165], v[44:45], v[100:101]
    v_pk_mul_f32 v[166:167], v[46:47], v[102:103]
    v_pk_fma_f32 v[160:161], v[52:53], v[100:101], v[160:161]
    v_pk_fma_f32 v[162:163], v[54:55], v[102:103], v[162:163]
    v_pk_fma_f32 v[164:165], v[52:53], v[96:97], v[164:165] neg_lo:[1,0,0] neg_hi:[1,0,0]
    v_pk_fma_f32 v[166:167], v[54:55], v[98:99], v[166:167] neg_lo:[1,0,0] neg_hi:[1,0,0]
    v_pk_mul_f32 v[168:169], v[48:49], v[104:105]
    v_pk_mul_f32 v[170:171], v[50:51], v[106:107]
    v_pk_mul_f32 v[172:173], v[48:49], v[108:109]
    v_pk_mul_f32 v[174:175], v[50:51], v[110:111]
    v_pk_fma_f32 v[168:169], v[56:57], v[108:109], v[168:169]
    v_pk_fma_f32 v[170:171], v[58:59], v[110:111], v[170:171]
    v_pk_fma_f32 v[172:173], v[56:57], v[104:105], v[172:173] neg_lo:[1,0,0] neg_hi:[1,0,0]
    v_pk_fma_f32 v[174:175], v[58:59], v[106:107], v[174:175] neg_lo:[1,0,0] neg_hi:[1,0,0]
    v_pk_mul_f32 v[176:177], v[44:45], v[112:113]
    v_pk_mul_f32 v[178:179], v[46:47], v[114:115]
    v_pk_mul_f32 v[180:181], v[44:45], v[116:117]
    v_pk_mul_f32 v[182:183], v[46:47], v[118:119]
    v_pk_fma_f32 v[176:177], v[52:53], v[116:117], v[176:177]
    v_pk_fma_f32 v[178:179], v[54:55], v[118:119], v[178:179]
    v_pk_fma_f32 v[180:181], v[52:53], v[112:113], v[180:181] neg_lo:[1,0,0] neg_hi:[1,0,0]
    v_pk_fma_f32 v[182:183], v[54:55], v[114:115], v[182:183] neg_lo:[1,0,0] neg_hi:[1,0,0]
    v_pk_mul_f32 v[184:185], v[48:49], v[120:121]
    v_pk_mul_f32 v[186:187], v[50:51], v[122:123]
    v_pk_mul_f32 v[188:189], v[48:49], v[124:125]
    v_pk_mul_f32 v[190:191], v[50:51], v[126:127]
    v_pk_fma_f32 v[184:185], v[56:57], v[124:125], v[184:185]
    v_pk_fma_f32 v[186:187], v[58:59], v[126:127], v[186:187]
    v_pk_fma_f32 v[188:189], v[56:57], v[120:121], v[188:189] neg_lo:[1,0,0] neg_hi:[1,0,0]
    v_pk_fma_f32 v[190:191], v[58:59], v[122:123], v[190:191] neg_lo:[1,0,0] neg_hi:[1,0,0]
    v_cvt_pk_bf16_f32 v64, v160, v164
    v_cvt_pk_bf16_f32 v65, v161, v165
    v_cvt_pk_bf16_f32 v66, v162, v166
    v_cvt_pk_bf16_f32 v67, v163, v167
    v_cvt_pk_bf16_f32 v68, v168, v172
    v_cvt_pk_bf16_f32 v69, v169, v173
    v_mfma_f32_16x16x32_bf16 v[128:131], v[64:67], v[28:31], 0
    v_cvt_pk_bf16_f32 v70, v170, v174
    v_cvt_pk_bf16_f32 v71, v171, v175
    v_mfma_f32_16x16x32_bf16 v[132:135], v[64:67], v[36:39], 0
    v_cvt_pk_bf16_f32 v72, v176, v180
    v_cvt_pk_bf16_f32 v73, v177, v181
    v_mfma_f32_16x16x32_bf16 v[128:131], v[68:71], v[32:35], v[128:131]
    v_cvt_pk_bf16_f32 v74, v178, v182
    v_cvt_pk_bf16_f32 v75, v179, v183
    v_mfma_f32_16x16x32_bf16 v[132:135], v[68:71], v[40:43], v[132:135]
    v_cvt_pk_bf16_f32 v76, v184, v188
    v_cvt_pk_bf16_f32 v77, v185, v189
    v_mfma_f32_16x16x32_bf16 v[136:139], v[72:75], v[28:31], 0
    v_cvt_pk_bf16_f32 v78, v186, v190
    v_cvt_pk_bf16_f32 v79, v187, v191
    v_mfma_f32_16x16x32_bf16 v[140:143], v[72:75], v[36:39], 0
    s_nop 0
    v_mfma_f32_16x16x32_bf16 v[136:139], v[76:79], v[32:35], v[136:139]
    v_mfma_f32_16x16x32_bf16 v[140:143], v[76:79], v[40:43], v[140:143]
    v_cvt_pk_bf16_f32 v144, v128, v129
    v_cvt_pk_bf16_f32 v145, v130, v131
    v_cvt_pk_bf16_f32 v146, v132, v133
    v_cvt_pk_bf16_f32 v147, v134, v135
    s_nop 0
    v_permlane16_swap_b32 v144, v146
    v_permlane16_swap_b32 v145, v147
    buffer_store_dwordx4 v[144:147], v11, s[24:27], s53 offen offset:1024 nt
    v_cvt_pk_bf16_f32 v148, v136, v137
    v_cvt_pk_bf16_f32 v149, v138, v139
    v_cvt_pk_bf16_f32 v150, v140, v141
    v_cvt_pk_bf16_f32 v151, v142, v143
    s_nop 0
    v_permlane16_swap_b32 v148, v150
    v_permlane16_swap_b32 v149, v151
    buffer_store_dwordx4 v[148:151], v11, s[24:27], s54 offen offset:1024 nt
    s_or_b32 s56, s2, s36
    s_cbranch_scc1 L_B_end
    v_mov_b32 v5, 5799936
    v_mov_b32 v6, s41
    buffer_store_dword v6, v5, s[28:31], 0 offen
L_B_end:
    s_endpgm
L_B_poll:
    s_mov_b32 s60, 0
L_B_polla:
    s_mov_b64 exec, vcc
    buffer_load_dword v10, v9, s[28:31], s52 offen sc1
    s_add_u32 s60, s60, 1
    s_waitcnt vmcnt(0)
    v_cmp_ne_u32 vcc, s41, v10
    s_mov_b64 exec, -1
    s_cbranch_vccz L_B_go
    s_cmp_lt_u32 s60, 524288
    s_cbranch_scc1 L_B_polla
    s_branch L_B_go
L_end:
    s_endpgm
.p2align 12
.section .rodata,"a"
.p2align 6
.amdhsa_kernel concat_heads__ssm_conv_h3__spectral_fnet__prompt_kernel
  .amdhsa_next_free_vgpr 256
  .amdhsa_next_free_sgpr 64
  .amdhsa_accum_offset 256
  .amdhsa_group_segment_fixed_size 0
  .amdhsa_kernarg_size 112
  .amdhsa_user_sgpr_count 2
  .amdhsa_user_sgpr_kernarg_segment_ptr 1
  .amdhsa_system_sgpr_workgroup_id_x 1
.end_amdhsa_kernel
```
